```python
import torch

def _softmax(x, axis=-1):
    return torch.softmax(x, dim=axis)
def _gelu(x):
    return torch.nn.functional.gelu(x, approximate="tanh")
def _silu(x):
    return torch.nn.functional.silu(x)
def _sigmoid(x):
    return torch.sigmoid(x)
def _layernorm(x, axis=-1, eps=1e-5):
    m = x.mean(dim=axis, keepdim=True)
    v = x.var(dim=axis, keepdim=True, unbiased=False)
    return (x - m) / torch.sqrt(v + eps)
def _scatter_add(tgt, idx, src, axis=0):
    return tgt.clone().index_add_(axis, idx, src)
def _segment_sum(src, seg, n):
    out = torch.zeros((n,) + src.shape[1:], dtype=src.dtype)
    return out.index_add_(0, seg, src)
def _pad(x, pw):
    flat = tuple(v for pair in reversed(pw) for v in pair)
    return torch.nn.functional.pad(x, flat)

kernel_name = 'parallel_sum__mha_block_cached__glu_gated_glu__decode'

def setup_inputs():

    _w = (lambda a: (lambda t: t.to(torch.bfloat16) if t.is_floating_point() else t)(torch.as_tensor(a)))
    def _A_setup():
        B, Sq, D = 1, 1, 1024
        H, Sk, Dh = 32, 65536, 128
        return {
            "x": _w((lambda *s: torch.randn(*s, dtype=torch.bfloat16) * 0.05)(B, Sq, D)),
            "k_cache": _w((lambda *s: torch.randn(*s, dtype=torch.bfloat16) * 3.2)(B, H, Sk, Dh)),
            "v_cache": _w((lambda *s: torch.randn(*s, dtype=torch.bfloat16) * 1.6)(B, H, Sk, Dh)),
            "wq": _w((lambda *s: torch.randn(*s, dtype=torch.bfloat16) * 3.2)(D, H * Dh) * (D ** -0.5)),
            "wo": _w((lambda *s: torch.randn(*s, dtype=torch.bfloat16) * 1.6)(H * Dh, D) * ((H * Dh) ** -0.5)),
        }
    _A_in = _A_setup()

    def _B_setup():
        B, S, D, F = 1, 1, 1024, 3584
        return {
            "x": _w((lambda *s: torch.randn(*s, dtype=torch.bfloat16) * 0.05)(B, S, D)),
            "w_gate": _w((lambda *s: torch.randn(*s, dtype=torch.bfloat16) * 0.05)(D, F)),
            "w_up": _w((lambda *s: torch.randn(*s, dtype=torch.bfloat16) * 0.05)(D, F)),
            "w_down": _w((lambda *s: torch.randn(*s, dtype=torch.bfloat16) * 0.05)(F, D)),
        }
    _B_in = _B_setup()

    return {
        "A_x": _A_in["x"],
        "A_k_cache": _A_in["k_cache"],
        "A_v_cache": _A_in["v_cache"],
        "A_wq": _A_in["wq"],
        "A_wo": _A_in["wo"],
        "B_x": _B_in["x"],
        "B_w_gate": _B_in["w_gate"],
        "B_w_up": _B_in["w_up"],
        "B_w_down": _B_in["w_down"],
    }

def reference(A_x, A_k_cache, A_v_cache, A_wq, A_wo, B_x, B_w_gate, B_w_up, B_w_down):
    def _A_ref(x, k_cache, v_cache, wq, wo):
        B, Sq, D = x.shape
        H, Dh = 32, 128
        q = (lambda x, *d: x.permute(*d))((x @ wq).reshape(B, Sq, H, Dh), 0, 2, 1, 3)
        scores = torch.einsum("bhqd,bhkd->bhqk", q, k_cache) * (Dh ** -0.5)
        p = _softmax(scores, axis=-1)
        o = torch.einsum("bhqk,bhkd->bhqd", p, v_cache)
        return (lambda x, *d: x.permute(*d))(o, 0, 2, 1, 3).reshape(B, Sq, H * Dh) @ wo

    def _B_ref(x, w_gate, w_up, w_down):
        g = torch.einsum("bsd,df->bsf", x, w_gate)
        u = torch.einsum("bsd,df->bsf", x, w_up)
        h = _sigmoid(g) * u
        return torch.einsum("bsf,fd->bsd", h, w_down)

    x = A_x
    xn = _layernorm(x, axis=-1)
    return x + _A_ref(xn, A_k_cache, A_v_cache, A_wq, A_wo) + _B_ref(xn, B_w_gate, B_w_up, B_w_down)
```

```asm
; @launch grid=(256,1,1) block=(384,1,1) lds=37888
.amdgcn_target "amdgcn-amd-amdhsa--gfx950"
.text
.globl parallel_sum__mha_block_cached__glu_gated_glu__decode_kernel
.p2align 8
.type parallel_sum__mha_block_cached__glu_gated_glu__decode_kernel,@function
parallel_sum__mha_block_cached__glu_gated_glu__decode_kernel:
  s_cmp_ge_u32 s2, 256
  s_cbranch_scc1 L_end
  s_load_dwordx16 s[4:19], s[0:1], 0
  s_load_dwordx8 s[20:27], s[0:1], 64
  v_lshrrev_b32 v1, 6, v0
  v_and_b32 v0, 63, v0
  v_readfirstlane_b32 s3, v1
  s_lshr_b32 s48, s2, 3
  s_and_b32 s49, s2, 7
  s_cmp_eq_u32 s3, 4
  s_cbranch_scc0 L_nocpre
  s_cmp_lt_u32 s48, (L_codeend-parallel_sum__mha_block_cached__glu_gated_glu__decode_kernel)>>10
  s_cbranch_scc0 L_nocpre
  s_getpc_b64 s[60:61]
L_pc:
  s_lshl_b32 s58, s48, 10
  s_sub_u32 s58, s58, L_pc-parallel_sum__mha_block_cached__glu_gated_glu__decode_kernel
  s_ashr_i32 s59, s58, 31
  s_add_u32 s60, s60, s58
  s_addc_u32 s61, s61, s59
  v_lshlrev_b32 v16, 4, v0
  v_mov_b32 v17, s61
  v_add_co_u32 v16, vcc, s60, v16
  s_nop 1
  v_addc_co_u32 v17, vcc, 0, v17, vcc
  global_load_dwordx4 v[20:23], v[16:17], off
L_nocpre:
  s_mov_b32 s31, 0x20000
  s_mov_b32 s35, s31
  s_mov_b32 s39, s31
  s_mov_b32 s30, 2162688
  s_movk_i32 s34, 2048
  v_and_b32 v1, 15, v0
  v_lshrrev_b32 v2, 4, v0
  s_cmp_lg_u32 s3, 0
  s_cbranch_scc1 L_notq
  s_setprio 3
  v_lshlrev_b32 v16, 5, v0
  v_lshlrev_b32 v15, 2, v0
  s_lshl_b32 s59, s49, 8
  v_lshlrev_b32 v14, 18, v2
  v_lshl_add_u32 v14, v1, 4, v14
  s_lshl_b32 s58, s49, 12
  s_add_u32 s58, s58, s48
  s_lshl_b32 s58, s58, 8
  s_mov_b32 s38, 8388608
  s_movk_i32 s60, 8192
  s_waitcnt lgkmcnt(0)
  s_mov_b32 s28, s26
  s_mov_b32 s29, s27
  s_mov_b32 s32, s4
  s_mov_b32 s33, s5
  s_mov_b32 s36, s10
  s_mov_b32 s37, s11
  buffer_load_dwordx4 v[4:7], v16, s[32:35], 0 offen
  buffer_load_dwordx4 v[8:11], v16, s[32:35], 0 offen offset:16
  buffer_load_dword v12, v15, s[32:35], s59 offen
  buffer_load_dword v13, off, s[28:31], 0 sc1
L_wissue:
  buffer_load_dwordx4 a[0:3], v14, s[36:39], s58 offen nt
  s_add_u32 s58, s58, s60
  buffer_load_dwordx4 a[4:7], v14, s[36:39], s58 offen nt
  s_add_u32 s58, s58, s60
  buffer_load_dwordx4 a[8:11], v14, s[36:39], s58 offen nt
  s_add_u32 s58, s58, s60
  buffer_load_dwordx4 a[12:15], v14, s[36:39], s58 offen nt
  s_add_u32 s58, s58, s60
  buffer_load_dwordx4 a[16:19], v14, s[36:39], s58 offen nt
  s_add_u32 s58, s58, s60
  buffer_load_dwordx4 a[20:23], v14, s[36:39], s58 offen nt
  s_add_u32 s58, s58, s60
  buffer_load_dwordx4 a[24:27], v14, s[36:39], s58 offen nt
  s_add_u32 s58, s58, s60
  buffer_load_dwordx4 a[28:31], v14, s[36:39], s58 offen nt
  s_add_u32 s58, s58, s60
  buffer_load_dwordx4 a[32:35], v14, s[36:39], s58 offen nt
  s_add_u32 s58, s58, s60
  buffer_load_dwordx4 a[36:39], v14, s[36:39], s58 offen nt
  s_add_u32 s58, s58, s60
  buffer_load_dwordx4 a[40:43], v14, s[36:39], s58 offen nt
  s_add_u32 s58, s58, s60
  buffer_load_dwordx4 a[44:47], v14, s[36:39], s58 offen nt
  s_add_u32 s58, s58, s60
  buffer_load_dwordx4 a[48:51], v14, s[36:39], s58 offen nt
  s_add_u32 s58, s58, s60
  buffer_load_dwordx4 a[52:55], v14, s[36:39], s58 offen nt
  s_add_u32 s58, s58, s60
  buffer_load_dwordx4 a[56:59], v14, s[36:39], s58 offen nt
  s_add_u32 s58, s58, s60
  buffer_load_dwordx4 a[60:63], v14, s[36:39], s58 offen nt
  s_add_u32 s58, s58, s60
  buffer_load_dwordx4 a[64:67], v14, s[36:39], s58 offen nt
  s_add_u32 s58, s58, s60
  buffer_load_dwordx4 a[68:71], v14, s[36:39], s58 offen nt
  s_add_u32 s58, s58, s60
  buffer_load_dwordx4 a[72:75], v14, s[36:39], s58 offen nt
  s_add_u32 s58, s58, s60
  buffer_load_dwordx4 a[76:79], v14, s[36:39], s58 offen nt
  s_add_u32 s58, s58, s60
  buffer_load_dwordx4 a[80:83], v14, s[36:39], s58 offen nt
  s_add_u32 s58, s58, s60
  buffer_load_dwordx4 a[84:87], v14, s[36:39], s58 offen nt
  s_add_u32 s58, s58, s60
  buffer_load_dwordx4 a[88:91], v14, s[36:39], s58 offen nt
  s_add_u32 s58, s58, s60
  buffer_load_dwordx4 a[92:95], v14, s[36:39], s58 offen nt
  s_add_u32 s58, s58, s60
  buffer_load_dwordx4 a[96:99], v14, s[36:39], s58 offen nt
  s_add_u32 s58, s58, s60
  buffer_load_dwordx4 a[100:103], v14, s[36:39], s58 offen nt
  s_add_u32 s58, s58, s60
  buffer_load_dwordx4 a[104:107], v14, s[36:39], s58 offen nt
  s_add_u32 s58, s58, s60
  buffer_load_dwordx4 a[108:111], v14, s[36:39], s58 offen nt
  s_add_u32 s58, s58, s60
  buffer_load_dwordx4 a[112:115], v14, s[36:39], s58 offen nt
  s_add_u32 s58, s58, s60
  buffer_load_dwordx4 a[116:119], v14, s[36:39], s58 offen nt
  s_add_u32 s58, s58, s60
  buffer_load_dwordx4 a[120:123], v14, s[36:39], s58 offen nt
  s_add_u32 s58, s58, s60
  buffer_load_dwordx4 a[124:127], v14, s[36:39], s58 offen nt
  s_cmp_lg_u32 s3, 0
  s_cbranch_scc1 L_h_common
  v_mov_b32 v16, 0
  v_mov_b32 v17, 0
  v_mov_b32 v18, 0
  v_mov_b32 v19, 0
  v_mov_b32 v20, 114
  v_mov_b32 v21, 114
  v_mov_b32 v22, 0
  v_mov_b32 v23, 0
  ds_write_b128 v16, v[16:19] offset:256
  ds_write_b128 v16, v[16:19] offset:272
  ds_write_b128 v16, v[20:23] offset:288
  ds_write_b32 v16, v16 offset:304
  s_lshl_b32 s64, s2, 9
  s_add_u32 s64, s64, 65536
  s_waitcnt lgkmcnt(0)
  s_barrier
L_h_common:
  v_lshlrev_b32 v3, 4, v0
  v_mov_b32 v73, 0
  s_add_u32 s42, s48, s49
  s_and_b32 s51, s42, 7
  s_and_b32 s42, s42, 31
  s_mov_b32 s52, 0xaaaaaaaa
  s_mov_b32 s53, s52
  s_mov_b32 s54, 0xcccccccc
  s_mov_b32 s55, s54
  s_mov_b32 s56, 0xff00ff00
  s_mov_b32 s57, s56
  v_mov_b32 v41, 1
  ds_add_u32 v73, v41 offset:300
  v_mov_b32 v41, 0x0c0c0c0c
  v_mov_b32 v42, 0x0c0c0100
  v_mov_b32 v43, 0x01000c0c
  v_cndmask_b32 v42, v42, v43, s[52:53]
  v_mov_b32 v43, 0x0c0c0302
  v_mov_b32 v44, 0x03020c0c
  v_cndmask_b32 v43, v43, v44, s[52:53]
  s_mov_b32 s58, 50529027
  s_mov_b32 s59, s58
  v_cndmask_b32 v32, v41, v42, s[58:59]
  v_cndmask_b32 v36, v41, v43, s[58:59]
  s_mov_b32 s58, 202116108
  s_mov_b32 s59, s58
  v_cndmask_b32 v33, v41, v42, s[58:59]
  v_cndmask_b32 v37, v41, v43, s[58:59]
  s_mov_b32 s58, 808464432
  s_mov_b32 s59, s58
  v_cndmask_b32 v34, v41, v42, s[58:59]
  v_cndmask_b32 v38, v41, v43, s[58:59]
  s_mov_b32 s58, 3233857728
  s_mov_b32 s59, s58
  v_cndmask_b32 v35, v41, v42, s[58:59]
  v_cndmask_b32 v39, v41, v43, s[58:59]
  v_lshlrev_b32 v62, 7, v2
  v_lshl_add_u32 v62, v1, 4, v62
  v_mov_b32 v63, 2146435072
  v_cndmask_b32 v62, v62, v63, s[56:57]
  v_mov_b32 v63, 3
  s_mov_b32 s46, 2162688
  s_waitcnt vmcnt(32)
  v_readfirstlane_b32 s45, v13
  v_lshlrev_b32 v16, 16, v4
  v_and_b32 v17, 0xffff0000, v4
  v_lshlrev_b32 v18, 16, v5
  v_and_b32 v19, 0xffff0000, v5
  v_lshlrev_b32 v20, 16, v6
  v_and_b32 v21, 0xffff0000, v6
  v_lshlrev_b32 v22, 16, v7
  v_and_b32 v23, 0xffff0000, v7
  v_lshlrev_b32 v24, 16, v8
  v_and_b32 v25, 0xffff0000, v8
  v_lshlrev_b32 v26, 16, v9
  v_and_b32 v27, 0xffff0000, v9
  v_lshlrev_b32 v28, 16, v10
  v_and_b32 v29, 0xffff0000, v10
  v_lshlrev_b32 v30, 16, v11
  v_and_b32 v31, 0xffff0000, v11
  s_add_u32 s45, s45, 1
  s_or_b32 s45, s45, 0x80000000
  s_and_b32 s14, s45, 3
  s_add_u32 s15, s45, 106
  s_and_b32 s15, s15, 3
  s_add_u32 s24, s45, 197
  s_and_b32 s24, s24, 3
  s_add_u32 s25, s45, 59
  s_and_b32 s25, s25, 3
  v_add_f32 v4, v16, v17
  v_add_f32 v5, v18, v19
  v_add_f32 v6, v20, v21
  v_add_f32 v7, v22, v23
  v_add_f32 v8, v24, v25
  v_add_f32 v9, v26, v27
  v_add_f32 v10, v28, v29
  v_add_f32 v11, v30, v31
  v_add_f32 v4, v4, v8
  v_add_f32 v5, v5, v9
  v_add_f32 v6, v6, v10
  v_add_f32 v7, v7, v11
  v_add_f32 v4, v4, v5
  v_add_f32 v6, v6, v7
  v_add_f32 v4, v4, v6
  s_nop 1
  v_add_f32_dpp v4, v4, v4 row_ror:8 row_mask:0xf bank_mask:0xf
  s_nop 1
  v_add_f32_dpp v4, v4, v4 row_ror:4 row_mask:0xf bank_mask:0xf
  s_nop 1
  v_add_f32_dpp v4, v4, v4 row_ror:2 row_mask:0xf bank_mask:0xf
  s_nop 1
  v_add_f32_dpp v4, v4, v4 row_ror:1 row_mask:0xf bank_mask:0xf
  v_mov_b32 v5, v4
  s_nop 1
  v_permlane16_swap_b32 v4, v5
  v_add_f32 v4, v4, v5
  v_mov_b32 v5, v4
  s_nop 1
  v_permlane32_swap_b32 v4, v5
  v_add_f32 v4, v4, v5
  v_mul_f32 v4, 0x3a800000, v4
  v_sub_f32 v16, v16, v4
  v_sub_f32 v17, v17, v4
  v_sub_f32 v18, v18, v4
  v_sub_f32 v19, v19, v4
  v_sub_f32 v20, v20, v4
  v_sub_f32 v21, v21, v4
  v_sub_f32 v22, v22, v4
  v_sub_f32 v23, v23, v4
  v_sub_f32 v24, v24, v4
  v_sub_f32 v25, v25, v4
  v_sub_f32 v26, v26, v4
  v_sub_f32 v27, v27, v4
  v_sub_f32 v28, v28, v4
  v_sub_f32 v29, v29, v4
  v_sub_f32 v30, v30, v4
  v_sub_f32 v31, v31, v4
  v_mul_f32 v6, v16, v16
  v_mul_f32 v7, v17, v17
  v_mul_f32 v8, v18, v18
  v_mul_f32 v9, v19, v19
  v_fmac_f32 v6, v20, v20
  v_fmac_f32 v7, v21, v21
  v_fmac_f32 v8, v22, v22
  v_fmac_f32 v9, v23, v23
  v_fmac_f32 v6, v24, v24
  v_fmac_f32 v7, v25, v25
  v_fmac_f32 v8, v26, v26
  v_fmac_f32 v9, v27, v27
  v_fmac_f32 v6, v28, v28
  v_fmac_f32 v7, v29, v29
  v_fmac_f32 v8, v30, v30
  v_fmac_f32 v9, v31, v31
  v_add_f32 v6, v6, v7
  v_add_f32 v8, v8, v9
  v_add_f32 v6, v6, v8
  s_nop 1
  v_add_f32_dpp v6, v6, v6 row_ror:8 row_mask:0xf bank_mask:0xf
  s_nop 1
  v_add_f32_dpp v6, v6, v6 row_ror:4 row_mask:0xf bank_mask:0xf
  s_nop 1
  v_add_f32_dpp v6, v6, v6 row_ror:2 row_mask:0xf bank_mask:0xf
  s_nop 1
  v_add_f32_dpp v6, v6, v6 row_ror:1 row_mask:0xf bank_mask:0xf
  v_mov_b32 v5, v6
  s_nop 1
  v_permlane16_swap_b32 v6, v5
  v_add_f32 v6, v6, v5
  v_mov_b32 v5, v6
  s_nop 1
  v_permlane32_swap_b32 v6, v5
  v_add_f32 v6, v6, v5
  v_mul_f32 v6, 0x3a800000, v6
  v_cvt_pk_bf16_f32 v4, v4, v4
  v_lshlrev_b32 v4, 16, v4
  v_cvt_pk_bf16_f32 v6, v6, v6
  v_lshlrev_b32 v6, 16, v6
  v_add_f32 v6, 925353388, v6
  v_cvt_pk_bf16_f32 v6, v6, v6
  v_lshlrev_b32 v6, 16, v6
  v_sqrt_f32 v6, v6
  s_nop 0
  v_cvt_pk_bf16_f32 v6, v6, v6
  v_lshlrev_b32 v6, 16, v6
  v_rcp_f32 v6, v6
  v_lshlrev_b32 v8, 16, v12
  v_and_b32 v9, 0xffff0000, v12
  v_sub_f32 v8, v8, v4
  v_sub_f32 v9, v9, v4
  v_cvt_pk_bf16_f32 v8, v8, v9
  v_and_b32 v9, 0xffff0000, v8
  v_lshlrev_b32 v8, 16, v8
  v_mul_f32 v8, v8, v6
  v_mul_f32 v9, v9, v6
  v_cvt_pk_bf16_f32 v40, v8, v9
  s_nop 1
  s_call_b64 s[80:81], F_chain
  s_cmp_eq_u32 s3, 1
  s_cbranch_scc1 L_warm
  v_mov_b32 v102, 0
  s_cmp_eq_u32 s3, 4
  s_cbranch_scc1 L_uwave
  s_mov_b32 s50, 0
  s_lshl_b32 s66, s48, 12
  s_add_u32 s66, s66, 65536
  v_bfe_u32 v99, v0, 3, 2
  v_lshlrev_b32 v99, 6, v99
  v_and_b32 v98, 32, v0
  v_add_u32 v99, v99, v98
  v_and_b32 v98, 7, v0
  v_lshl_add_u32 v99, v98, 1, v99
  v_mov_b32 v103, s45
  s_nop 1
  s_call_b64 s[80:81], F_gather4
  v_cvt_pk_bf16_f32 v96, v96, v97
  ds_write_b16 v99, v96
  ds_write_b16_d16_hi v99, v96 offset:16
  s_waitcnt lgkmcnt(0)
  ds_write_b32 v102, v103 offset:256
  s_cmp_lt_u32 s42, 28
  s_cbranch_scc0 L_fin
  s_mov_b32 s43, s49
  s_mov_b32 s36, s20
  s_mov_b32 s37, s21
  s_mov_b32 s38, 7340032
  v_and_b32 v14, 1, v2
  v_lshlrev_b32 v14, 17, v14
  v_lshrrev_b32 v15, 1, v2
  v_lshl_add_u32 v14, v15, 15, v14
  v_lshl_add_u32 v14, v1, 4, v14
  v_mov_b32 v15, v14
  s_mul_i32 s67, s42, 262144
  s_lshl_b32 s58, s43, 8
  s_add_u32 s67, s67, s58
  s_mov_b32 s70, 1600000
L_lw1:
  ds_read_b32 v60, v102 offset:264
  s_waitcnt lgkmcnt(0)
  v_readfirstlane_b32 s59, v60
  s_nop 0
  s_cmp_ge_u32 s59, 2
  s_cbranch_scc1 L_lw1_ok
  s_sub_u32 s70, s70, 1
  s_cmp_eq_u32 s70, 0
  s_cbranch_scc1 L_lw1_ok
  s_sleep 16
  s_branch L_lw1
L_lw1_ok:
  s_lshl_b32 s47, s42, 9
  s_add_u32 s47, s47, 36864
  v_lshlrev_b32 v98, 3, v0
  s_and_b32 s58, s42, 7
  s_cmp_eq_u32 s58, s49
  s_cbranch_scc1 L_hred
  s_mov_b32 s70, 1600000
L_lw2:
  ds_read_b32 v60, v102 offset:264
  s_waitcnt lgkmcnt(0)
  v_readfirstlane_b32 s59, v60
  s_nop 0
  s_cmp_ge_u32 s59, 5
  s_cbranch_scc1 L_lw2_ok
  s_sub_u32 s70, s70, 1
  s_cmp_eq_u32 s70, 0
  s_cbranch_scc1 L_lw2_ok
  s_sleep 16
  s_branch L_lw2
L_lw2_ok:
  s_mov_b32 s70, 200000
L_hx:
  buffer_load_dwordx2 v[40:41], v98, s[28:31], s47 offen sc1
  s_waitcnt vmcnt(0)
  v_cmp_ne_u32 vcc, s45, v41
  s_cbranch_vccz L_hok
  s_sleep 48
  s_sub_u32 s70, s70, 1
  s_cmp_lg_u32 s70, 0
  s_cbranch_scc1 L_hx
  s_branch L_hok
L_hred:
  s_mov_b32 s50, 1
  s_lshl_b32 s65, s42, 12
  s_add_u32 s66, s65, 196608
  s_call_b64 s[80:81], F_gather4
  v_cvt_pk_bf16_f32 v100, v96, v96
  v_lshlrev_b32 v100, 16, v100
  v_cvt_pk_bf16_f32 v101, v97, v97
  v_lshlrev_b32 v101, 16, v101
  s_add_u32 s66, s65, 327680
  s_nop 0
  s_call_b64 s[80:81], F_gather4
  v_cvt_pk_bf16_f32 v96, v96, v96
  v_lshlrev_b32 v96, 16, v96
  v_cvt_pk_bf16_f32 v97, v97, v97
  v_lshlrev_b32 v97, 16, v97
  v_mul_f32 v100, 0xbfb8aa3b, v100
  v_exp_f32 v100, v100
  s_nop 0
  v_add_f32 v100, 1.0, v100
  v_rcp_f32 v100, v100
  s_nop 0
  v_cvt_pk_bf16_f32 v100, v100, v100
  v_lshlrev_b32 v100, 16, v100
  v_mul_f32 v101, 0xbfb8aa3b, v101
  v_exp_f32 v101, v101
  s_nop 0
  v_add_f32 v101, 1.0, v101
  v_rcp_f32 v101, v101
  s_nop 0
  v_cvt_pk_bf16_f32 v101, v101, v101
  v_lshlrev_b32 v101, 16, v101
  v_mul_f32 v96, v96, v100
  v_mul_f32 v97, v97, v101
  v_cvt_pk_bf16_f32 v40, v96, v97
  v_mov_b32 v41, s45
  buffer_store_dwordx2 v[40:41], v98, s[28:31], s47 offen sc1
L_hok:
  s_lshl_b32 s64, s43, 5
  s_add_u32 s64, s64, s42
  s_lshl_b32 s64, s64, 9
  s_add_u32 s64, s64, 458752
  v_mov_b32 v63, 0xff
  s_and_b32 s14, s45, 255
  s_add_u32 s15, s45, 106
  s_and_b32 s15, s15, 255
  s_add_u32 s24, s45, 197
  s_and_b32 s24, s24, 255
  s_add_u32 s25, s45, 59
  s_and_b32 s25, s25, 255
  s_add_u32 s46, s64, 1048576
  s_mov_b32 s38, 0
  s_mov_b32 s44, 0
  s_branch L_ld
L_ldw:
  s_mov_b32 s38, 7340032
  s_mov_b32 s44, 1
  s_waitcnt vmcnt(0)
  s_mov_b32 s70, 1600000
L_lw3:
  ds_read_b32 v60, v102 offset:296
  s_waitcnt lgkmcnt(0)
  v_readfirstlane_b32 s59, v60
  s_nop 0
  s_cmp_ge_u32 s59, 1
  s_cbranch_scc1 L_lw3_ok
  s_sub_u32 s70, s70, 1
  s_cmp_eq_u32 s70, 0
  s_cbranch_scc1 L_lw3_ok
  s_sleep 3
  s_branch L_lw3
L_lw3_ok:
L_ld:
  s_add_u32 s58, s67, 0
  buffer_load_dwordx4 a[0:3], v14, s[36:39], s58 offen nt
  s_add_u32 s58, s67, 16384
  buffer_load_dwordx4 a[4:7], v14, s[36:39], s58 offen nt
  s_add_u32 s58, s67, 2048
  buffer_load_dwordx4 a[8:11], v14, s[36:39], s58 offen nt
  s_add_u32 s58, s67, 18432
  buffer_load_dwordx4 a[12:15], v14, s[36:39], s58 offen nt
  s_add_u32 s58, s67, 4096
  buffer_load_dwordx4 a[16:19], v14, s[36:39], s58 offen nt
  s_add_u32 s58, s67, 20480
  buffer_load_dwordx4 a[20:23], v14, s[36:39], s58 offen nt
  s_add_u32 s58, s67, 6144
  buffer_load_dwordx4 a[24:27], v14, s[36:39], s58 offen nt
  s_add_u32 s58, s67, 22528
  buffer_load_dwordx4 a[28:31], v14, s[36:39], s58 offen nt
  s_add_u32 s58, s67, 8192
  buffer_load_dwordx4 a[32:35], v14, s[36:39], s58 offen nt
  s_add_u32 s58, s67, 24576
  buffer_load_dwordx4 a[36:39], v14, s[36:39], s58 offen nt
  s_add_u32 s58, s67, 10240
  buffer_load_dwordx4 a[40:43], v14, s[36:39], s58 offen nt
  s_add_u32 s58, s67, 26624
  buffer_load_dwordx4 a[44:47], v14, s[36:39], s58 offen nt
  s_add_u32 s58, s67, 12288
  buffer_load_dwordx4 a[48:51], v14, s[36:39], s58 offen nt
  s_add_u32 s58, s67, 28672
  buffer_load_dwordx4 a[52:55], v14, s[36:39], s58 offen nt
  s_add_u32 s58, s67, 14336
  buffer_load_dwordx4 a[56:59], v14, s[36:39], s58 offen nt
  s_add_u32 s58, s67, 30720
  buffer_load_dwordx4 a[60:63], v14, s[36:39], s58 offen nt
  s_add_u32 s58, s67, 65536
  buffer_load_dwordx4 a[64:67], v15, s[36:39], s58 offen nt
  s_add_u32 s58, s67, 81920
  buffer_load_dwordx4 a[68:71], v15, s[36:39], s58 offen nt
  s_add_u32 s58, s67, 67584
  buffer_load_dwordx4 a[72:75], v15, s[36:39], s58 offen nt
  s_add_u32 s58, s67, 83968
  buffer_load_dwordx4 a[76:79], v15, s[36:39], s58 offen nt
  s_waitcnt vmcnt(19)
  s_add_u32 s58, s67, 69632
  buffer_load_dwordx4 a[80:83], v15, s[36:39], s58 offen nt
  s_waitcnt vmcnt(19)
  s_add_u32 s58, s67, 86016
  buffer_load_dwordx4 a[84:87], v15, s[36:39], s58 offen nt
  s_waitcnt vmcnt(19)
  s_add_u32 s58, s67, 71680
  buffer_load_dwordx4 a[88:91], v15, s[36:39], s58 offen nt
  s_waitcnt vmcnt(19)
  s_add_u32 s58, s67, 88064
  buffer_load_dwordx4 a[92:95], v15, s[36:39], s58 offen nt
  s_waitcnt vmcnt(19)
  s_add_u32 s58, s67, 73728
  buffer_load_dwordx4 a[96:99], v15, s[36:39], s58 offen nt
  s_waitcnt vmcnt(19)
  s_add_u32 s58, s67, 90112
  buffer_load_dwordx4 a[100:103], v15, s[36:39], s58 offen nt
  s_waitcnt vmcnt(19)
  s_add_u32 s58, s67, 75776
  buffer_load_dwordx4 a[104:107], v15, s[36:39], s58 offen nt
  s_waitcnt vmcnt(19)
  s_add_u32 s58, s67, 92160
  buffer_load_dwordx4 a[108:111], v15, s[36:39], s58 offen nt
  s_waitcnt vmcnt(19)
  s_add_u32 s58, s67, 77824
  buffer_load_dwordx4 a[112:115], v15, s[36:39], s58 offen nt
  s_waitcnt vmcnt(19)
  s_add_u32 s58, s67, 94208
  buffer_load_dwordx4 a[116:119], v15, s[36:39], s58 offen nt
  s_waitcnt vmcnt(19)
  s_add_u32 s58, s67, 79872
  buffer_load_dwordx4 a[120:123], v15, s[36:39], s58 offen nt
  s_waitcnt vmcnt(19)
  s_add_u32 s58, s67, 96256
  buffer_load_dwordx4 a[124:127], v15, s[36:39], s58 offen nt
  s_cmp_eq_u32 s44, 0
  s_cbranch_scc1 L_ldw
  s_call_b64 s[80:81], F_chain
  s_branch L_fin
L_uwave:
  s_setprio 0
  s_mov_b32 s70, 1600000
L_lw4:
  ds_read_b64 v[60:61], v102 offset:264
  s_waitcnt lgkmcnt(0)
  v_min_u32 v60, v60, v61
  s_nop 0
  v_readfirstlane_b32 s58, v60
  s_nop 0
  s_cmp_ge_u32 s58, 63
  s_cbranch_scc1 L_lw4_ok
  s_sub_u32 s70, s70, 1
  s_cmp_eq_u32 s70, 0
  s_cbranch_scc1 L_lw4_ok
  s_sleep 64
  s_branch L_lw4
L_lw4_ok:
  s_mov_b32 s70, 1600000
L_lw5:
  ds_read_b32 v60, v102 offset:260
  s_waitcnt lgkmcnt(0)
  v_readfirstlane_b32 s58, v60
  s_nop 0
  s_cmp_ge_u32 s58, 1
  s_cbranch_scc1 L_lw5_ok
  s_sub_u32 s70, s70, 1
  s_cmp_eq_u32 s70, 0
  s_cbranch_scc1 L_lw5_ok
  s_sleep 1
  s_branch L_lw5
L_lw5_ok:
  v_mov_b32 v4, 0xff7fffff
  v_mov_b32 v5, 0
  v_mov_b32 v6, v3
  s_mov_b32 s60, 8
L_ls0:
  ds_read_b128 v[16:19], v6 offset:1024
  ds_read_b128 v[20:23], v6 offset:2048
  ds_read_b128 v[24:27], v6 offset:3072
  ds_read_b128 v[28:31], v6 offset:4096
  v_add_u32 v6, 4096, v6
  s_waitcnt lgkmcnt(0)
  v_max3_f32 v4, v16, v17, v4
  v_max3_f32 v4, v18, v19, v4
  v_max3_f32 v4, v20, v21, v4
  v_max3_f32 v4, v22, v23, v4
  v_max3_f32 v4, v24, v25, v4
  v_max3_f32 v4, v26, v27, v4
  v_max3_f32 v4, v28, v29, v4
  v_max3_f32 v4, v30, v31, v4
  s_sub_u32 s60, s60, 1
  s_cmp_lg_u32 s60, 0
  s_cbranch_scc1 L_ls0
  v_max_f32_dpp v4, v4, v4 row_ror:8 row_mask:0xf bank_mask:0xf
  s_nop 1
  v_max_f32_dpp v4, v4, v4 row_ror:4 row_mask:0xf bank_mask:0xf
  s_nop 1
  v_max_f32_dpp v4, v4, v4 row_ror:2 row_mask:0xf bank_mask:0xf
  s_nop 1
  v_max_f32_dpp v4, v4, v4 row_ror:1 row_mask:0xf bank_mask:0xf
  v_mov_b32 v7, v4
  s_nop 1
  v_permlane16_swap_b32 v4, v7
  v_max_f32 v4, v4, v7
  v_mov_b32 v7, v4
  s_nop 1
  v_permlane32_swap_b32 v4, v7
  v_max_f32 v4, v4, v7
  v_mov_b32 v6, v3
  s_mov_b32 s60, 8
L_ls1:
  ds_read_b128 v[16:19], v6 offset:1024
  ds_read_b128 v[20:23], v6 offset:2048
  ds_read_b128 v[24:27], v6 offset:3072
  ds_read_b128 v[28:31], v6 offset:4096
  v_add_u32 v6, 4096, v6
  s_waitcnt lgkmcnt(0)
  v_sub_f32 v16, v16, v4
  v_sub_f32 v17, v17, v4
  v_sub_f32 v18, v18, v4
  v_sub_f32 v19, v19, v4
  v_sub_f32 v20, v20, v4
  v_sub_f32 v21, v21, v4
  v_sub_f32 v22, v22, v4
  v_sub_f32 v23, v23, v4
  v_sub_f32 v24, v24, v4
  v_sub_f32 v25, v25, v4
  v_sub_f32 v26, v26, v4
  v_sub_f32 v27, v27, v4
  v_sub_f32 v28, v28, v4
  v_sub_f32 v29, v29, v4
  v_sub_f32 v30, v30, v4
  v_sub_f32 v31, v31, v4
  v_mul_f32 v16, 1069066811, v16
  v_mul_f32 v17, 1069066811, v17
  v_mul_f32 v18, 1069066811, v18
  v_mul_f32 v19, 1069066811, v19
  v_mul_f32 v20, 1069066811, v20
  v_mul_f32 v21, 1069066811, v21
  v_mul_f32 v22, 1069066811, v22
  v_mul_f32 v23, 1069066811, v23
  v_mul_f32 v24, 1069066811, v24
  v_mul_f32 v25, 1069066811, v25
  v_mul_f32 v26, 1069066811, v26
  v_mul_f32 v27, 1069066811, v27
  v_mul_f32 v28, 1069066811, v28
  v_mul_f32 v29, 1069066811, v29
  v_mul_f32 v30, 1069066811, v30
  v_mul_f32 v31, 1069066811, v31
  v_exp_f32 v16, v16
  v_exp_f32 v17, v17
  v_exp_f32 v18, v18
  v_exp_f32 v19, v19
  v_exp_f32 v20, v20
  v_exp_f32 v21, v21
  v_exp_f32 v22, v22
  v_exp_f32 v23, v23
  v_exp_f32 v24, v24
  v_exp_f32 v25, v25
  v_exp_f32 v26, v26
  v_exp_f32 v27, v27
  v_exp_f32 v28, v28
  v_exp_f32 v29, v29
  v_exp_f32 v30, v30
  v_exp_f32 v31, v31
  v_add_f32 v5, v5, v16
  v_add_f32 v5, v5, v17
  v_add_f32 v5, v5, v18
  v_add_f32 v5, v5, v19
  v_add_f32 v5, v5, v20
  v_add_f32 v5, v5, v21
  v_add_f32 v5, v5, v22
  v_add_f32 v5, v5, v23
  v_add_f32 v5, v5, v24
  v_add_f32 v5, v5, v25
  v_add_f32 v5, v5, v26
  v_add_f32 v5, v5, v27
  v_add_f32 v5, v5, v28
  v_add_f32 v5, v5, v29
  v_add_f32 v5, v5, v30
  v_add_f32 v5, v5, v31
  s_sub_u32 s60, s60, 1
  s_cmp_lg_u32 s60, 0
  s_cbranch_scc1 L_ls1
  v_add_f32_dpp v5, v5, v5 row_ror:8 row_mask:0xf bank_mask:0xf
  s_nop 1
  v_add_f32_dpp v5, v5, v5 row_ror:4 row_mask:0xf bank_mask:0xf
  s_nop 1
  v_add_f32_dpp v5, v5, v5 row_ror:2 row_mask:0xf bank_mask:0xf
  s_nop 1
  v_add_f32_dpp v5, v5, v5 row_ror:1 row_mask:0xf bank_mask:0xf
  v_mov_b32 v7, v5
  s_nop 1
  v_permlane16_swap_b32 v5, v7
  v_add_f32 v5, v5, v7
  v_mov_b32 v7, v5
  s_nop 1
  v_permlane32_swap_b32 v5, v7
  v_add_f32 v5, v5, v7
  v_log_f32 v8, v5
  v_mov_b32 v7, 1069066811
  v_fmac_f32 v8, v4, v7
  v_mov_b32 v9, s45
  s_not_b32 s58, s45
  v_mov_b32 v10, s58
  v_mov_b32 v11, s45
  s_lshl_b32 s58, s2, 7
  s_add_u32 s58, s58, 4096
  s_mov_b64 exec, 1
  buffer_store_dwordx4 v[8:11], off, s[28:31], s58 sc1
  s_mov_b64 exec, -1
  v_and_b32 v6, 7, v0
  v_lshlrev_b32 v6, 7, v6
  s_lshl_b32 s58, s48, 10
  s_add_u32 s58, s58, 4096
  s_mov_b32 s70, 200000
L_lx:
  s_sleep 100
  buffer_load_dwordx4 v[12:15], v6, s[28:31], s58 offen sc1
  s_waitcnt vmcnt(0)
  v_xor_b32 v13, v13, v9
  v_xor_b32 v14, v14, v10
  v_or_b32 v13, v13, v14
  v_cmp_ne_u32 vcc, 0, v13
  s_cbranch_vccz L_lx_ok
  s_sub_u32 s70, s70, 1
  s_cmp_lg_u32 s70, 0
  s_cbranch_scc1 L_lx
L_lx_ok:
  v_mov_b32 v4, v12
  s_nop 1
  v_max_f32_dpp v4, v4, v4 row_ror:4 row_mask:0xf bank_mask:0xf
  s_nop 1
  v_max_f32_dpp v4, v4, v4 row_ror:2 row_mask:0xf bank_mask:0xf
  s_nop 1
  v_max_f32_dpp v4, v4, v4 row_ror:1 row_mask:0xf bank_mask:0xf
  v_sub_f32 v12, v12, v4
  v_exp_f32 v12, v12
  s_nop 1
  v_add_f32_dpp v12, v12, v12 row_ror:4 row_mask:0xf bank_mask:0xf
  s_nop 1
  v_add_f32_dpp v12, v12, v12 row_ror:2 row_mask:0xf bank_mask:0xf
  s_nop 1
  v_add_f32_dpp v12, v12, v12 row_ror:1 row_mask:0xf bank_mask:0xf
  v_log_f32 v12, v12
  v_mov_b32 v13, 1
  v_add_f32 v12, v12, v4
  ds_write_b64 v102, v[12:13] offset:272
  s_cmp_ge_u32 s48, 16
  s_cbranch_scc1 L_fin
  v_and_b32 v59, 1, v0
  s_lshl_b32 s58, s48, 1
  s_and_b32 s58, s58, 31
  v_add_u32 v59, s58, v59
  v_lshrrev_b32 v77, 1, v0
  v_lshlrev_b32 v77, 9, v77
  v_lshl_add_u32 v77, v59, 4, v77
  v_cmp_gt_u32 vcc, 56, v0
  v_mov_b32 v86, 2146435072
  s_nop 0
  v_cndmask_b32 v86, v86, v77, vcc
  v_cndmask_b32 v87, 0, -1, vcc
  v_lshrrev_b32 v78, 3, v59
  v_lshlrev_b32 v78, 5, v78
  v_and_b32 v60, 7, v59
  v_add_u32 v78, v78, v60
  v_lshl_add_u32 v78, v2, 3, v78
  s_lshl_b32 s58, s49, 7
  v_add_u32 v78, s58, v78
  v_lshlrev_b32 v78, 1, v78
  buffer_load_ushort v120, v78, s[32:35], 0 offen
  s_lshl_b32 s58, s49, 14
  s_add_u32 s8, s58, 1900544
  s_add_u32 s9, s58, 2031616
  s_add_u32 s10, s58, 1507328
  v_mov_b32 v85, 0xff
  s_and_b32 s14, s45, 255
  s_add_u32 s15, s45, 106
  s_and_b32 s15, s15, 255
  s_add_u32 s24, s45, 197
  s_and_b32 s24, s24, 255
  s_add_u32 s25, s45, 59
  s_and_b32 s25, s25, 255
  s_waitcnt vmcnt(0)
  s_mov_b32 s32, s22
  s_mov_b32 s33, s23
  v_lshlrev_b32 v120, 16, v120
  s_setprio 3
  s_mov_b32 s30, 0
  s_mov_b32 s34, 0
  s_mov_b32 s14, 0
  s_mov_b32 s15, 0
  s_mov_b32 s24, 0
  s_mov_b32 s25, 0
  s_mov_b32 s44, 0
  s_branch L_zdry
L_zreal:
  s_mov_b64 exec, -1
  s_mov_b32 s30, 2162688
  s_movk_i32 s34, 2048
  s_and_b32 s14, s45, 255
  s_add_u32 s15, s45, 106
  s_and_b32 s15, s15, 255
  s_add_u32 s24, s45, 197
  s_and_b32 s24, s24, 255
  s_add_u32 s25, s45, 59
  s_and_b32 s25, s25, 255
  s_mov_b32 s44, 1
  s_mov_b32 s70, 1600000
L_lw6:
  ds_read_b32 v60, v102 offset:304
  s_waitcnt lgkmcnt(0)
  v_readfirstlane_b32 s58, v60
  s_nop 0
  s_cmp_ge_u32 s58, 1
  s_cbranch_scc1 L_lw6_ok
  s_sub_u32 s70, s70, 1
  s_cmp_eq_u32 s70, 0
  s_cbranch_scc1 L_lw6_ok
  s_sleep 2
  s_branch L_lw6
L_lw6_ok:
L_zdry:
  s_mov_b32 s70, 200000
L_zg:
  buffer_load_dwordx4 v[88:91], v77, s[28:31], s8 offen sc1
  buffer_load_dwordx4 v[92:95], v77, s[28:31], s9 offen sc1
  buffer_load_dwordx4 v[96:99], v86, s[28:31], s10 offen sc1
  s_waitcnt vmcnt(0)
  v_xor_b32 v96, s14, v96
  v_xor_b32 v97, s15, v97
  v_xor_b32 v98, s24, v98
  v_xor_b32 v99, s25, v99
  v_and_b32 v36, v96, v87
  v_and_b32 v37, v97, v87
  v_and_b32 v38, v98, v87
  v_and_b32 v39, v99, v87
  v_or3_b32 v40, v36, v37, v38
  v_or_b32 v40, v40, v39
  v_xor_b32 v88, s14, v88
  v_xor_b32 v89, s15, v89
  v_xor_b32 v90, s24, v90
  v_xor_b32 v91, s25, v91
  v_xor_b32 v92, s14, v92
  v_xor_b32 v93, s15, v93
  v_xor_b32 v94, s24, v94
  v_xor_b32 v95, s25, v95
  v_or3_b32 v48, v88, v89, v90
  v_or3_b32 v49, v91, v92, v93
  v_or3_b32 v50, v94, v95, v40
  v_or3_b32 v51, v48, v49, v50
  v_and_b32 v51, v85, v51
  v_cmp_ne_u32 vcc, 0, v51
  s_cbranch_vccz L_zg_ok
  s_wqm_b64 exec, vcc
  s_cmp_eq_u32 s70, 199976
  s_cselect_b32 s58, 1048576, 0
  s_sub_u32 s8, s8, s58
  s_sub_u32 s9, s9, s58
  s_sub_u32 s10, s10, s58
  s_sub_u32 s70, s70, 1
  s_cmp_lg_u32 s70, 0
  s_cbranch_scc1 L_zg
L_zg_ok:
  s_mov_b64 exec, -1
  v_add_f32 v32, v88, v92
  v_add_f32 v33, v89, v93
  v_add_f32 v34, v90, v94
  v_add_f32 v35, v91, v95
  v_permlane32_swap_b32 v36, v38
  v_permlane32_swap_b32 v37, v39
  v_permlane32_swap_b32 v32, v34
  v_permlane32_swap_b32 v33, v35
  v_add_f32 v36, v36, v38
  v_add_f32 v37, v37, v39
  v_add_f32 v32, v32, v34
  v_add_f32 v33, v33, v35
  v_permlane16_swap_b32 v36, v37
  s_nop 0
  v_permlane16_swap_b32 v32, v33
  v_add_f32 v36, v36, v37
  v_add_f32 v32, v32, v33
  s_nop 0
  v_add_f32_dpp v36, v36, v36 quad_perm:[2,3,0,1] row_mask:0xf bank_mask:0xf
  v_add_f32_dpp v32, v32, v32 quad_perm:[2,3,0,1] row_mask:0xf bank_mask:0xf
  s_nop 0
  v_add_f32_dpp v36, v36, v36 row_ror:4 row_mask:0xf bank_mask:0xf
  v_add_f32_dpp v32, v32, v32 row_ror:4 row_mask:0xf bank_mask:0xf
  s_nop 0
  v_add_f32_dpp v36, v36, v36 row_ror:8 row_mask:0xf bank_mask:0xf
  v_add_f32_dpp v32, v32, v32 row_ror:8 row_mask:0xf bank_mask:0xf
  v_cvt_pk_bf16_f32 v32, v32, v36
  v_and_b32 v36, 0xffff0000, v32
  v_lshlrev_b32 v32, 16, v32
  v_add_f32 v32, v120, v32
  v_cvt_pk_bf16_f32 v32, v32, v32
  v_lshlrev_b32 v32, 16, v32
  v_add_f32 v32, v32, v36
  v_cvt_pk_bf16_f32 v32, v32, v32
  s_mov_b32 exec_lo, 0x00030003
  s_mov_b32 exec_hi, 0x00030003
  buffer_store_short v32, v78, s[32:35], 0 offen
  s_cmp_eq_u32 s2, 0
  s_cbranch_scc0 L_ufin
  s_mov_b64 exec, 1
  v_mov_b32 v33, s45
  buffer_store_dword v33, off, s[28:31], 0 sc1
L_ufin:
  s_cmp_eq_u32 s44, 0
  s_cbranch_scc1 L_zreal
  s_branch L_fin
L_warm:
  s_setprio 0
  s_waitcnt vmcnt(0)
  s_mov_b32 s30, 0
  s_mov_b32 s34, 0
  s_mov_b32 s38, 0
  s_mov_b32 s11, 0
  s_mov_b32 s14, 0
  s_mov_b32 s15, 0
  s_mov_b32 s24, 0
  s_mov_b32 s25, 0
  v_mov_b32 v119, 0
  v_mov_b32 v58, 0
  v_mov_b32 v121, 0
  v_mov_b32 v4, 0
  v_mov_b32 v6, 0
  v_mov_b32 v24, 0
  v_mov_b32 v25, 0
  v_mov_b32 v26, 0
  v_mov_b32 v27, 0
  v_mov_b32 v44, 0
  v_mov_b32 v45, 0
  v_mov_b32 v46, 0
  v_mov_b32 v47, 0
  v_mov_b32 v70, 0
  v_mov_b32 v72, 0
  v_mov_b32 v75, 0
  v_mov_b32 v76, 0
  v_mov_b32 v77, 0
  v_mov_b32 v78, 0
  v_mov_b32 v80, 0
  v_mov_b32 v81, 0
  v_mov_b32 v82, 0
  v_mov_b32 v83, 0
  v_mov_b32 v84, 0
  v_mov_b32 v85, 0
  v_mov_b32 v86, 0
  v_mov_b32 v87, 0
  v_mov_b32 v120, 0
  v_mov_b32 v122, 0
  v_mov_b32 v123, 0
  v_mov_b32 v77, 2048
  v_mov_b32 v78, 2048
  v_mov_b32 v58, 512
  v_mov_b32 v73, 512
  v_mov_b32 v74, 512
  v_mov_b32 v69, 128
  v_mov_b32 v79, 128
  v_mov_b32 v7, 0xff7fffff
  v_lshlrev_b32 v60, 2, v1
  ds_write_b32 v60, v69 offset:768
  s_mov_b32 s4, 0
  s_mov_b32 s5, 0
  s_mov_b32 s6, 0
  s_mov_b32 s7, 0
  s_mov_b32 s8, 0
  s_mov_b32 s9, 0
  s_mov_b32 s10, 0
  s_mov_b32 s47, 0
  s_mov_b32 s48, 0
  s_mov_b32 s64, 0
  s_mov_b32 s71, 0
  s_mov_b32 s72, 0
  s_mov_b32 s74, 0
  s_mov_b32 s75, 0
  s_mov_b32 s76, 0
  s_mov_b32 s60, 2
  s_mov_b32 s68, 2
  s_mov_b32 s69, 8
  s_mov_b32 s77, 128
  s_mov_b32 s65, 0
  s_mov_b32 s66, 0
  s_movk_i32 s67, 256
  s_mov_b32 s61, 0
  s_mov_b32 s40, s36
  s_mov_b32 s41, s37
  s_mov_b32 s46, 0
  s_mov_b32 s73, 0
  s_branch L_step
F_chain:
  v_mov_b32_dpp v41, v40 row_newbcast:0 row_mask:0xf bank_mask:0xf
  v_perm_b32 v44, v41, v41, v32
  v_perm_b32 v45, v41, v41, v33
  v_perm_b32 v46, v41, v41, v34
  v_perm_b32 v47, v41, v41, v35
  v_perm_b32 v48, v41, v41, v36
  v_perm_b32 v49, v41, v41, v37
  v_perm_b32 v50, v41, v41, v38
  v_perm_b32 v51, v41, v41, v39
  s_waitcnt vmcnt(30)
  v_mfma_f32_16x16x32_bf16 v[52:55], a[0:3], v[44:47], 0
  v_mov_b32_dpp v42, v40 row_newbcast:1 row_mask:0xf bank_mask:0xf
  v_perm_b32 v44, v42, v42, v32
  v_perm_b32 v45, v42, v42, v33
  v_perm_b32 v46, v42, v42, v34
  v_perm_b32 v47, v42, v42, v35
  v_mfma_f32_16x16x32_bf16 v[52:55], a[4:7], v[48:51], v[52:55]
  v_perm_b32 v48, v42, v42, v36
  v_perm_b32 v49, v42, v42, v37
  v_perm_b32 v50, v42, v42, v38
  v_perm_b32 v51, v42, v42, v39
  s_waitcnt vmcnt(28)
  v_mfma_f32_16x16x32_bf16 v[52:55], a[8:11], v[44:47], v[52:55]
  v_mov_b32_dpp v41, v40 row_newbcast:2 row_mask:0xf bank_mask:0xf
  v_perm_b32 v44, v41, v41, v32
  v_perm_b32 v45, v41, v41, v33
  v_perm_b32 v46, v41, v41, v34
  v_perm_b32 v47, v41, v41, v35
  v_mfma_f32_16x16x32_bf16 v[52:55], a[12:15], v[48:51], v[52:55]
  v_perm_b32 v48, v41, v41, v36
  v_perm_b32 v49, v41, v41, v37
  v_perm_b32 v50, v41, v41, v38
  v_perm_b32 v51, v41, v41, v39
  s_waitcnt vmcnt(26)
  v_mfma_f32_16x16x32_bf16 v[52:55], a[16:19], v[44:47], v[52:55]
  v_mov_b32_dpp v42, v40 row_newbcast:3 row_mask:0xf bank_mask:0xf
  v_perm_b32 v44, v42, v42, v32
  v_perm_b32 v45, v42, v42, v33
  v_perm_b32 v46, v42, v42, v34
  v_perm_b32 v47, v42, v42, v35
  v_mfma_f32_16x16x32_bf16 v[52:55], a[20:23], v[48:51], v[52:55]
  v_perm_b32 v48, v42, v42, v36
  v_perm_b32 v49, v42, v42, v37
  v_perm_b32 v50, v42, v42, v38
  v_perm_b32 v51, v42, v42, v39
  s_waitcnt vmcnt(24)
  v_mfma_f32_16x16x32_bf16 v[52:55], a[24:27], v[44:47], v[52:55]
  v_mov_b32_dpp v41, v40 row_newbcast:4 row_mask:0xf bank_mask:0xf
  v_perm_b32 v44, v41, v41, v32
  v_perm_b32 v45, v41, v41, v33
  v_perm_b32 v46, v41, v41, v34
  v_perm_b32 v47, v41, v41, v35
  v_mfma_f32_16x16x32_bf16 v[52:55], a[28:31], v[48:51], v[52:55]
  v_perm_b32 v48, v41, v41, v36
  v_perm_b32 v49, v41, v41, v37
  v_perm_b32 v50, v41, v41, v38
  v_perm_b32 v51, v41, v41, v39
  s_waitcnt vmcnt(22)
  v_mfma_f32_16x16x32_bf16 v[52:55], a[32:35], v[44:47], v[52:55]
  v_mov_b32_dpp v42, v40 row_newbcast:5 row_mask:0xf bank_mask:0xf
  v_perm_b32 v44, v42, v42, v32
  v_perm_b32 v45, v42, v42, v33
  v_perm_b32 v46, v42, v42, v34
  v_perm_b32 v47, v42, v42, v35
  v_mfma_f32_16x16x32_bf16 v[52:55], a[36:39], v[48:51], v[52:55]
  v_perm_b32 v48, v42, v42, v36
  v_perm_b32 v49, v42, v42, v37
  v_perm_b32 v50, v42, v42, v38
  v_perm_b32 v51, v42, v42, v39
  s_waitcnt vmcnt(20)
  v_mfma_f32_16x16x32_bf16 v[52:55], a[40:43], v[44:47], v[52:55]
  v_mov_b32_dpp v41, v40 row_newbcast:6 row_mask:0xf bank_mask:0xf
  v_perm_b32 v44, v41, v41, v32
  v_perm_b32 v45, v41, v41, v33
  v_perm_b32 v46, v41, v41, v34
  v_perm_b32 v47, v41, v41, v35
  v_mfma_f32_16x16x32_bf16 v[52:55], a[44:47], v[48:51], v[52:55]
  v_perm_b32 v48, v41, v41, v36
  v_perm_b32 v49, v41, v41, v37
  v_perm_b32 v50, v41, v41, v38
  v_perm_b32 v51, v41, v41, v39
  s_waitcnt vmcnt(18)
  v_mfma_f32_16x16x32_bf16 v[52:55], a[48:51], v[44:47], v[52:55]
  v_mov_b32_dpp v42, v40 row_newbcast:7 row_mask:0xf bank_mask:0xf
  v_perm_b32 v44, v42, v42, v32
  v_perm_b32 v45, v42, v42, v33
  v_perm_b32 v46, v42, v42, v34
  v_perm_b32 v47, v42, v42, v35
  v_mfma_f32_16x16x32_bf16 v[52:55], a[52:55], v[48:51], v[52:55]
  v_perm_b32 v48, v42, v42, v36
  v_perm_b32 v49, v42, v42, v37
  v_perm_b32 v50, v42, v42, v38
  v_perm_b32 v51, v42, v42, v39
  s_waitcnt vmcnt(16)
  v_mfma_f32_16x16x32_bf16 v[52:55], a[56:59], v[44:47], v[52:55]
  v_mov_b32_dpp v41, v40 row_newbcast:8 row_mask:0xf bank_mask:0xf
  v_perm_b32 v44, v41, v41, v32
  v_perm_b32 v45, v41, v41, v33
  v_perm_b32 v46, v41, v41, v34
  v_perm_b32 v47, v41, v41, v35
  v_mfma_f32_16x16x32_bf16 v[52:55], a[60:63], v[48:51], v[52:55]
  v_perm_b32 v48, v41, v41, v36
  v_perm_b32 v49, v41, v41, v37
  v_perm_b32 v50, v41, v41, v38
  v_perm_b32 v51, v41, v41, v39
  s_waitcnt vmcnt(14)
  v_mfma_f32_16x16x32_bf16 v[52:55], a[64:67], v[44:47], v[52:55]
  v_mov_b32_dpp v42, v40 row_newbcast:9 row_mask:0xf bank_mask:0xf
  v_perm_b32 v44, v42, v42, v32
  v_perm_b32 v45, v42, v42, v33
  v_perm_b32 v46, v42, v42, v34
  v_perm_b32 v47, v42, v42, v35
  v_mfma_f32_16x16x32_bf16 v[52:55], a[68:71], v[48:51], v[52:55]
  v_perm_b32 v48, v42, v42, v36
  v_perm_b32 v49, v42, v42, v37
  v_perm_b32 v50, v42, v42, v38
  v_perm_b32 v51, v42, v42, v39
  s_waitcnt vmcnt(12)
  v_mfma_f32_16x16x32_bf16 v[52:55], a[72:75], v[44:47], v[52:55]
  v_mov_b32_dpp v41, v40 row_newbcast:10 row_mask:0xf bank_mask:0xf
  v_perm_b32 v44, v41, v41, v32
  v_perm_b32 v45, v41, v41, v33
  v_perm_b32 v46, v41, v41, v34
  v_perm_b32 v47, v41, v41, v35
  v_mfma_f32_16x16x32_bf16 v[52:55], a[76:79], v[48:51], v[52:55]
  v_perm_b32 v48, v41, v41, v36
  v_perm_b32 v49, v41, v41, v37
  v_perm_b32 v50, v41, v41, v38
  v_perm_b32 v51, v41, v41, v39
  s_waitcnt vmcnt(10)
  v_mfma_f32_16x16x32_bf16 v[52:55], a[80:83], v[44:47], v[52:55]
  v_mov_b32_dpp v42, v40 row_newbcast:11 row_mask:0xf bank_mask:0xf
  v_perm_b32 v44, v42, v42, v32
  v_perm_b32 v45, v42, v42, v33
  v_perm_b32 v46, v42, v42, v34
  v_perm_b32 v47, v42, v42, v35
  v_mfma_f32_16x16x32_bf16 v[52:55], a[84:87], v[48:51], v[52:55]
  v_perm_b32 v48, v42, v42, v36
  v_perm_b32 v49, v42, v42, v37
  v_perm_b32 v50, v42, v42, v38
  v_perm_b32 v51, v42, v42, v39
  s_waitcnt vmcnt(8)
  v_mfma_f32_16x16x32_bf16 v[52:55], a[88:91], v[44:47], v[52:55]
  v_mov_b32_dpp v41, v40 row_newbcast:12 row_mask:0xf bank_mask:0xf
  v_perm_b32 v44, v41, v41, v32
  v_perm_b32 v45, v41, v41, v33
  v_perm_b32 v46, v41, v41, v34
  v_perm_b32 v47, v41, v41, v35
  v_mfma_f32_16x16x32_bf16 v[52:55], a[92:95], v[48:51], v[52:55]
  v_perm_b32 v48, v41, v41, v36
  v_perm_b32 v49, v41, v41, v37
  v_perm_b32 v50, v41, v41, v38
  v_perm_b32 v51, v41, v41, v39
  s_waitcnt vmcnt(6)
  v_mfma_f32_16x16x32_bf16 v[52:55], a[96:99], v[44:47], v[52:55]
  v_mov_b32_dpp v42, v40 row_newbcast:13 row_mask:0xf bank_mask:0xf
  v_perm_b32 v44, v42, v42, v32
  v_perm_b32 v45, v42, v42, v33
  v_perm_b32 v46, v42, v42, v34
  v_perm_b32 v47, v42, v42, v35
  v_mfma_f32_16x16x32_bf16 v[52:55], a[100:103], v[48:51], v[52:55]
  v_perm_b32 v48, v42, v42, v36
  v_perm_b32 v49, v42, v42, v37
  v_perm_b32 v50, v42, v42, v38
  v_perm_b32 v51, v42, v42, v39
  s_waitcnt vmcnt(4)
  v_mfma_f32_16x16x32_bf16 v[52:55], a[104:107], v[44:47], v[52:55]
  v_mov_b32_dpp v41, v40 row_newbcast:14 row_mask:0xf bank_mask:0xf
  v_perm_b32 v44, v41, v41, v32
  v_perm_b32 v45, v41, v41, v33
  v_perm_b32 v46, v41, v41, v34
  v_perm_b32 v47, v41, v41, v35
  v_mfma_f32_16x16x32_bf16 v[52:55], a[108:111], v[48:51], v[52:55]
  v_perm_b32 v48, v41, v41, v36
  v_perm_b32 v49, v41, v41, v37
  v_perm_b32 v50, v41, v41, v38
  v_perm_b32 v51, v41, v41, v39
  s_waitcnt vmcnt(2)
  v_mfma_f32_16x16x32_bf16 v[52:55], a[112:115], v[44:47], v[52:55]
  v_mov_b32_dpp v42, v40 row_newbcast:15 row_mask:0xf bank_mask:0xf
  v_perm_b32 v44, v42, v42, v32
  v_perm_b32 v45, v42, v42, v33
  v_perm_b32 v46, v42, v42, v34
  v_perm_b32 v47, v42, v42, v35
  v_mfma_f32_16x16x32_bf16 v[52:55], a[116:119], v[48:51], v[52:55]
  v_perm_b32 v48, v42, v42, v36
  v_perm_b32 v49, v42, v42, v37
  v_perm_b32 v50, v42, v42, v38
  v_perm_b32 v51, v42, v42, v39
  s_waitcnt vmcnt(0)
  v_mfma_f32_16x16x32_bf16 v[52:55], a[120:123], v[44:47], v[52:55]
  v_mfma_f32_16x16x32_bf16 v[52:55], a[124:127], v[48:51], v[52:55]
  s_nop 7
  v_bfi_b32 v56, v63, s14, v52
  v_bfi_b32 v57, v63, s15, v53
  v_bfi_b32 v58, v63, s24, v54
  v_bfi_b32 v59, v63, s25, v55
  buffer_store_dwordx4 v[56:59], v62, s[28:31], s46 offen
  buffer_store_dwordx4 v[56:59], v62, s[28:31], s64 offen sc0 sc1
  s_nop 1
  s_setpc_b64 s[80:81]
F_gather4:
  s_mov_b32 s70, 200000
L_g4:
  buffer_load_dwordx4 v[64:67], v3, s[28:31], s66 offen offset:0 sc1
  buffer_load_dwordx4 v[68:71], v3, s[28:31], s66 offen offset:1024 sc1
  buffer_load_dwordx4 v[72:75], v3, s[28:31], s66 offen offset:2048 sc1
  buffer_load_dwordx4 v[76:79], v3, s[28:31], s66 offen offset:3072 sc1
  s_waitcnt vmcnt(0)
  v_xor_b32 v64, s14, v64
  v_xor_b32 v65, s15, v65
  v_xor_b32 v66, s24, v66
  v_xor_b32 v67, s25, v67
  v_xor_b32 v68, s14, v68
  v_xor_b32 v69, s15, v69
  v_xor_b32 v70, s24, v70
  v_xor_b32 v71, s25, v71
  v_xor_b32 v72, s14, v72
  v_xor_b32 v73, s15, v73
  v_xor_b32 v74, s24, v74
  v_xor_b32 v75, s25, v75
  v_xor_b32 v76, s14, v76
  v_xor_b32 v77, s15, v77
  v_xor_b32 v78, s24, v78
  v_xor_b32 v79, s25, v79
  v_or3_b32 v80, v64, v65, v66
  v_or3_b32 v81, v67, v68, v69
  v_or3_b32 v82, v70, v71, v72
  v_or3_b32 v83, v73, v74, v75
  v_or3_b32 v84, v76, v77, v78
  v_or3_b32 v85, v79, v80, v81
  v_or3_b32 v86, v82, v83, v84
  v_or_b32 v87, v85, v86
  v_and_b32 v87, 3, v87
  v_cmp_ne_u32 vcc, 0, v87
  s_cbranch_vccz L_g4_done
  s_sub_u32 s70, s70, 1
  s_cmp_eq_u32 s70, 0
  s_cbranch_scc1 L_g4_done
  s_cmp_eq_u32 s50, 0
  s_cbranch_scc1 L_g4
  s_sleep 48
  s_branch L_g4
L_g4_done:
  v_add_f32 v64, v64, v68
  v_add_f32 v72, v72, v76
  v_add_f32 v65, v65, v69
  v_add_f32 v73, v73, v77
  v_add_f32 v66, v66, v70
  v_add_f32 v74, v74, v78
  v_add_f32 v67, v67, v71
  v_add_f32 v75, v75, v79
  v_add_f32 v64, v64, v72
  v_add_f32 v65, v65, v73
  v_add_f32 v66, v66, v74
  v_add_f32 v67, v67, v75
  s_nop 0
  v_permlane32_swap_b32 v64, v66
  v_permlane32_swap_b32 v65, v67
  v_add_f32 v96, v64, v66
  v_add_f32 v97, v65, v67
  s_nop 1
  s_setpc_b64 s[80:81]
L_notq:
  v_lshlrev_b32 v3, 4, v0
  v_mov_b32 v73, 0
  s_add_u32 s42, s48, s49
  s_and_b32 s51, s42, 7
  s_and_b32 s42, s42, 31
  s_mov_b32 s52, 0xaaaaaaaa
  s_mov_b32 s53, s52
  s_mov_b32 s54, 0xcccccccc
  s_mov_b32 s55, s54
  s_mov_b32 s56, 0xff00ff00
  s_mov_b32 s57, s56
  s_sub_u32 s72, s3, 2
  s_cmp_lt_u32 s72, 2
  s_cbranch_scc1 L_kwave
  s_cmp_eq_u32 s3, 5
  s_cbranch_scc1 L_kwave
  s_setprio 3
  v_lshlrev_b32 v16, 5, v0
  v_lshlrev_b32 v15, 2, v0
  s_lshl_b32 s59, s49, 8
  s_waitcnt lgkmcnt(0)
  s_mov_b32 s28, s26
  s_mov_b32 s29, s27
  s_mov_b32 s32, s4
  s_mov_b32 s33, s5
  buffer_load_dwordx4 v[4:7], v16, s[32:35], 0 offen
  buffer_load_dwordx4 v[8:11], v16, s[32:35], 0 offen offset:16
  buffer_load_dword v12, v15, s[32:35], s59 offen
  buffer_load_dword v13, off, s[28:31], 0 sc1
  s_cmp_eq_u32 s3, 1
  s_cselect_b32 s36, s16, s18
  s_cselect_b32 s37, s17, s19
  s_mov_b32 s38, 7340032
  s_mov_b32 s58, 196608
  s_mov_b32 s59, 327680
  s_cselect_b32 s64, s58, s59
  s_lshl_b32 s58, s42, 3
  s_add_u32 s58, s58, s49
  s_lshl_b32 s58, s58, 9
  s_add_u32 s64, s64, s58
  s_mov_b32 s58, 229376
  v_mul_lo_u32 v14, v2, s58
  v_lshl_add_u32 v14, v1, 4, v14
  s_cmp_lt_u32 s42, 28
  s_cselect_b32 s38, s38, 0
  s_cselect_b32 s64, s64, 2162688
  s_mul_i32 s58, s49, 917504
  s_mul_i32 s59, s42, 256
  s_add_u32 s58, s58, s59
  s_movk_i32 s60, 7168
  s_barrier
  s_cmp_lt_u32 s42, 28
  s_cbranch_scc1 L_nmw
  s_mov_b32 s70, 1600000
L_lw7:
  ds_read_b32 v60, v73 offset:256
  s_waitcnt lgkmcnt(0)
  v_readfirstlane_b32 s59, v60
  s_nop 0
  s_cmp_ge_u32 s59, 1
  s_cbranch_scc1 L_lw7_ok
  s_sub_u32 s70, s70, 1
  s_cmp_eq_u32 s70, 0
  s_cbranch_scc1 L_lw7_ok
  s_sleep 2
  s_branch L_lw7
L_lw7_ok:
L_nmw:
  s_branch L_wissue
L_kwave:
  s_waitcnt lgkmcnt(0)
  s_mov_b32 s28, s26
  s_mov_b32 s29, s27
  s_mov_b32 s32, s4
  s_mov_b32 s33, s5
  s_lshl_b32 s58, s48, 24
  s_add_u32 s36, s6, s58
  s_addc_u32 s37, s7, 0
  s_mov_b32 s38, 16777216
  s_add_u32 s40, s8, s58
  s_addc_u32 s41, s9, 0
  v_bfe_u32 v4, v0, 2, 2
  v_lshlrev_b32 v4, 8, v4
  v_lshl_add_u32 v4, v2, 6, v4
  v_and_b32 v5, 3, v0
  v_lshl_add_u32 v4, v5, 4, v4
  s_mov_b32 s73, 0
  s_bfe_u32 s58, s51, 196608
  s_lshl_b32 s58, s58, 15
  s_add_u32 s73, s73, s58
  s_mul_i32 s63, s48, 2
  v_lshlrev_b32 v70, 2, v0
  s_cmp_eq_u32 s3, 5
  s_cbranch_scc1 L_twave
  s_lshl_b32 s58, s72, 12
  s_add_u32 s73, s73, s58
  s_mov_b32 s76, s63
  s_mov_b32 s74, s73
  s_bfe_u32 s58, s76, 393216
  s_lshl_b32 s58, s58, 18
  s_add_u32 s74, s74, s58
  s_add_u32 s76, s76, 1
  s_barrier
  s_mov_b32 s70, 1600000
L_lw8:
  ds_read_b32 v60, v73 offset:300
  s_waitcnt lgkmcnt(0)
  v_readfirstlane_b32 s58, v60
  s_nop 0
  s_cmp_ge_u32 s58, 192
  s_cbranch_scc1 L_lw8_ok
  s_sub_u32 s70, s70, 1
  s_cmp_eq_u32 s70, 0
  s_cbranch_scc1 L_lw8_ok
  s_sleep 1
  s_branch L_lw8
L_lw8_ok:
  buffer_load_dwordx4 a[64:67], v4, s[36:39], s74 offen offset:0 nt
  buffer_load_dwordx4 a[68:71], v4, s[36:39], s74 offen offset:1024 nt
  s_add_u32 s75, s74, 8192
  buffer_load_dwordx4 a[72:75], v4, s[36:39], s75 offen offset:0 nt
  buffer_load_dwordx4 a[76:79], v4, s[36:39], s75 offen offset:1024 nt
  buffer_load_dwordx4 a[80:83], v4, s[36:39], s74 offen offset:2048 nt
  buffer_load_dwordx4 a[84:87], v4, s[36:39], s74 offen offset:3072 nt
  s_add_u32 s75, s74, 8192
  buffer_load_dwordx4 a[88:91], v4, s[36:39], s75 offen offset:2048 nt
  buffer_load_dwordx4 a[92:95], v4, s[36:39], s75 offen offset:3072 nt
  s_add_u32 s75, s74, 16384
  buffer_load_dwordx4 a[96:99], v4, s[36:39], s75 offen offset:0 nt
  buffer_load_dwordx4 a[100:103], v4, s[36:39], s75 offen offset:1024 nt
  s_add_u32 s75, s74, 24576
  buffer_load_dwordx4 a[104:107], v4, s[36:39], s75 offen offset:0 nt
  buffer_load_dwordx4 a[108:111], v4, s[36:39], s75 offen offset:1024 nt
  s_add_u32 s75, s74, 16384
  buffer_load_dwordx4 a[112:115], v4, s[36:39], s75 offen offset:2048 nt
  buffer_load_dwordx4 a[116:119], v4, s[36:39], s75 offen offset:3072 nt
  s_add_u32 s75, s74, 24576
  buffer_load_dwordx4 a[120:123], v4, s[36:39], s75 offen offset:2048 nt
  buffer_load_dwordx4 a[124:127], v4, s[36:39], s75 offen offset:3072 nt
  s_mov_b32 s74, s73
  s_bfe_u32 s58, s76, 393216
  s_lshl_b32 s58, s58, 18
  s_add_u32 s74, s74, s58
  s_add_u32 s76, s76, 1
  buffer_load_dwordx4 a[0:3], v4, s[36:39], s74 offen offset:0 nt
  buffer_load_dwordx4 a[4:7], v4, s[36:39], s74 offen offset:1024 nt
  s_add_u32 s75, s74, 8192
  buffer_load_dwordx4 a[8:11], v4, s[36:39], s75 offen offset:0 nt
  buffer_load_dwordx4 a[12:15], v4, s[36:39], s75 offen offset:1024 nt
  buffer_load_dwordx4 a[16:19], v4, s[36:39], s74 offen offset:2048 nt
  buffer_load_dwordx4 a[20:23], v4, s[36:39], s74 offen offset:3072 nt
  s_add_u32 s75, s74, 8192
  buffer_load_dwordx4 a[24:27], v4, s[36:39], s75 offen offset:2048 nt
  buffer_load_dwordx4 a[28:31], v4, s[36:39], s75 offen offset:3072 nt
  s_add_u32 s75, s74, 16384
  buffer_load_dwordx4 a[32:35], v4, s[36:39], s75 offen offset:0 nt
  buffer_load_dwordx4 a[36:39], v4, s[36:39], s75 offen offset:1024 nt
  s_add_u32 s75, s74, 24576
  buffer_load_dwordx4 a[40:43], v4, s[36:39], s75 offen offset:0 nt
  buffer_load_dwordx4 a[44:47], v4, s[36:39], s75 offen offset:1024 nt
  s_add_u32 s75, s74, 16384
  buffer_load_dwordx4 a[48:51], v4, s[36:39], s75 offen offset:2048 nt
  buffer_load_dwordx4 a[52:55], v4, s[36:39], s75 offen offset:3072 nt
  s_add_u32 s75, s74, 24576
  buffer_load_dwordx4 a[56:59], v4, s[36:39], s75 offen offset:2048 nt
  buffer_load_dwordx4 a[60:63], v4, s[36:39], s75 offen offset:3072 nt
  s_mov_b32 s74, s73
  s_bfe_u32 s58, s76, 393216
  s_lshl_b32 s58, s58, 18
  s_add_u32 s74, s74, s58
  s_add_u32 s76, s76, 1
  s_mov_b32 s74, s73
  s_bfe_u32 s58, s76, 393216
  s_lshl_b32 s58, s58, 18
  s_add_u32 s74, s74, s58
  s_add_u32 s76, s76, 1
  s_branch L_kq
L_twave:
  s_add_u32 s76, s63, 2
  s_mov_b32 s74, s73
  s_bfe_u32 s58, s76, 393216
  s_lshl_b32 s58, s58, 18
  s_add_u32 s74, s74, s58
  s_add_u32 s76, s76, 1
  s_add_u32 s73, s73, 4096
  s_sub_u32 s76, s76, 1
  s_barrier
  s_mov_b32 s70, 1600000
L_lw9:
  ds_read_b32 v60, v73 offset:300
  s_waitcnt lgkmcnt(0)
  v_readfirstlane_b32 s58, v60
  s_nop 0
  s_cmp_ge_u32 s58, 192
  s_cbranch_scc1 L_lw9_ok
  s_sub_u32 s70, s70, 1
  s_cmp_eq_u32 s70, 0
  s_cbranch_scc1 L_lw9_ok
  s_sleep 2
  s_branch L_lw9
L_lw9_ok:
  buffer_load_dwordx4 a[0:3], v4, s[36:39], s74 offen offset:0 nt
  buffer_load_dwordx4 a[4:7], v4, s[36:39], s74 offen offset:1024 nt
  s_add_u32 s75, s74, 8192
  buffer_load_dwordx4 a[8:11], v4, s[36:39], s75 offen offset:0 nt
  buffer_load_dwordx4 a[12:15], v4, s[36:39], s75 offen offset:1024 nt
  buffer_load_dwordx4 a[16:19], v4, s[36:39], s74 offen offset:2048 nt
  buffer_load_dwordx4 a[20:23], v4, s[36:39], s74 offen offset:3072 nt
  s_add_u32 s75, s74, 8192
  buffer_load_dwordx4 a[24:27], v4, s[36:39], s75 offen offset:2048 nt
  buffer_load_dwordx4 a[28:31], v4, s[36:39], s75 offen offset:3072 nt
  s_add_u32 s75, s74, 16384
  buffer_load_dwordx4 a[32:35], v4, s[36:39], s75 offen offset:0 nt
  buffer_load_dwordx4 a[36:39], v4, s[36:39], s75 offen offset:1024 nt
  s_add_u32 s75, s74, 24576
  buffer_load_dwordx4 a[40:43], v4, s[36:39], s75 offen offset:0 nt
  buffer_load_dwordx4 a[44:47], v4, s[36:39], s75 offen offset:1024 nt
  s_add_u32 s75, s74, 16384
  buffer_load_dwordx4 a[48:51], v4, s[36:39], s75 offen offset:2048 nt
  buffer_load_dwordx4 a[52:55], v4, s[36:39], s75 offen offset:3072 nt
  s_add_u32 s75, s74, 24576
  buffer_load_dwordx4 a[56:59], v4, s[36:39], s75 offen offset:2048 nt
  buffer_load_dwordx4 a[60:63], v4, s[36:39], s75 offen offset:3072 nt
  s_mov_b32 s74, s73
  s_bfe_u32 s58, s76, 393216
  s_lshl_b32 s58, s58, 18
  s_add_u32 s74, s74, s58
  s_add_u32 s76, s76, 1
  buffer_load_dwordx4 a[64:67], v4, s[36:39], s74 offen offset:0 nt
  buffer_load_dwordx4 a[68:71], v4, s[36:39], s74 offen offset:1024 nt
  s_add_u32 s75, s74, 8192
  buffer_load_dwordx4 a[72:75], v4, s[36:39], s75 offen offset:0 nt
  buffer_load_dwordx4 a[76:79], v4, s[36:39], s75 offen offset:1024 nt
  buffer_load_dwordx4 a[80:83], v4, s[36:39], s74 offen offset:2048 nt
  buffer_load_dwordx4 a[84:87], v4, s[36:39], s74 offen offset:3072 nt
  s_add_u32 s75, s74, 8192
  buffer_load_dwordx4 a[88:91], v4, s[36:39], s75 offen offset:2048 nt
  buffer_load_dwordx4 a[92:95], v4, s[36:39], s75 offen offset:3072 nt
  s_add_u32 s75, s74, 16384
  buffer_load_dwordx4 a[96:99], v4, s[36:39], s75 offen offset:0 nt
  buffer_load_dwordx4 a[100:103], v4, s[36:39], s75 offen offset:1024 nt
  s_add_u32 s75, s74, 24576
  buffer_load_dwordx4 a[104:107], v4, s[36:39], s75 offen offset:0 nt
  buffer_load_dwordx4 a[108:111], v4, s[36:39], s75 offen offset:1024 nt
  s_add_u32 s75, s74, 16384
  buffer_load_dwordx4 a[112:115], v4, s[36:39], s75 offen offset:2048 nt
  buffer_load_dwordx4 a[116:119], v4, s[36:39], s75 offen offset:3072 nt
  s_add_u32 s75, s74, 24576
  buffer_load_dwordx4 a[120:123], v4, s[36:39], s75 offen offset:2048 nt
  buffer_load_dwordx4 a[124:127], v4, s[36:39], s75 offen offset:3072 nt
  s_mov_b32 s74, s73
  s_bfe_u32 s58, s76, 393216
  s_lshl_b32 s58, s58, 18
  s_add_u32 s74, s74, s58
  s_add_u32 s76, s76, 1
  v_mul_u32_u24 v90, 4, v0
  v_add_u32 v90, s48, v90
  v_lshlrev_b32 v90, 8, v90
  v_add_u32 v90, 1114112, v90
  s_cmp_lt_u32 s48, 4
  s_cselect_b32 s58, 41, 0
  v_cmp_gt_u32 vcc, s58, v0
  v_mov_b32 v91, 2146435072
  s_nop 0
  v_cndmask_b32 v92, v91, v90, vcc
  buffer_load_dword v91, v92, s[28:31], 0 offen sc1
L_kq:
  v_lshlrev_b32 v59, 6, v2
  v_lshl_add_u32 v69, v5, 4, v59
  s_lshl_b32 s46, s72, 14
  s_add_u32 s46, s46, 1024
  s_mov_b32 s60, 0
  s_add_u32 s64, s46, 256
  s_add_u32 s71, s46, 768
  s_mov_b32 s69, 61
  s_mov_b32 s68, 0
  s_mov_b32 s61, 1
  s_mov_b32 s77, 0
  s_mov_b32 s11, 8388608
  s_mov_b32 s65, 7
  s_mov_b32 s66, 0
  s_mov_b32 s67, 0
  s_lshl_b32 s58, s72, 2
  v_mov_b32 v74, s58
  v_xor_b32 v58, 4, v74
  v_mov_b32 v121, 0
  v_mov_b32 v6, 0
  v_mov_b32 v79, 114
  v_mov_b32 v60, 0xffff
  v_mov_b32 v61, 0xffff0000
  v_cndmask_b32 v60, v60, v61, s[52:53]
  s_mov_b32 s58, 50529027
  s_mov_b32 s59, s58
  v_cndmask_b32 v80, 0, v60, s[58:59]
  s_mov_b32 s58, 202116108
  s_mov_b32 s59, s58
  v_cndmask_b32 v81, 0, v60, s[58:59]
  s_mov_b32 s58, 808464432
  s_mov_b32 s59, s58
  v_cndmask_b32 v82, 0, v60, s[58:59]
  s_mov_b32 s58, 3233857728
  s_mov_b32 s59, s58
  v_cndmask_b32 v83, 0, v60, s[58:59]
  v_mov_b32 v44, 0
  v_mov_b32 v45, 0
  v_mov_b32 v46, 0
  v_mov_b32 v47, 0
  v_mov_b32 v7, 0xff7fffff
  v_lshlrev_b32 v75, 14, v2
  v_lshl_add_u32 v75, v1, 4, v75
  v_lshlrev_b32 v76, 9, v2
  v_lshl_add_u32 v76, v1, 4, v76
  s_lshl_b32 s58, s72, 8
  v_add_u32 v76, s58, v76
  v_lshlrev_b32 v84, 7, v2
  v_lshl_add_u32 v84, v1, 4, v84
  v_mov_b32 v59, 2146435072
  v_cndmask_b32 v84, v84, v59, s[56:57]
  v_mov_b32 v85, 0xff
  s_and_b32 s58, s72, 1
  s_lshl_b32 s58, s58, 10
  v_add_u32 v77, s58, v3
  v_xor_b32 v78, 1024, v77
  v_lshrrev_b32 v60, 5, v0
  v_cmp_eq_u32 vcc, s72, v60
  s_nop 1
  v_cndmask_b32 v86, v59, v84, vcc
  s_mov_b32 s70, 1600000
L_lw10:
  ds_read_b32 v60, v73 offset:256
  s_waitcnt lgkmcnt(0)
  v_readfirstlane_b32 s45, v60
  s_nop 0
  s_cmp_ge_u32 s45, 1
  s_cbranch_scc1 L_lw10_ok
  s_sub_u32 s70, s70, 1
  s_cmp_eq_u32 s70, 0
  s_cbranch_scc1 L_lw10_ok
  s_sleep 1
  s_branch L_lw10
L_lw10_ok:
  ds_read_b128 v[60:63], v69
  s_and_b32 s14, s45, 255
  s_add_u32 s15, s45, 106
  s_and_b32 s15, s15, 255
  s_add_u32 s24, s45, 197
  s_and_b32 s24, s24, 255
  s_add_u32 s25, s45, 59
  s_and_b32 s25, s25, 255
  s_waitcnt lgkmcnt(0)
  s_mov_b32 s58, 983055
  s_mov_b32 s59, s58
  v_cndmask_b32 v8, 0, v60, s[58:59]
  v_cndmask_b32 v9, 0, v61, s[58:59]
  v_cndmask_b32 v10, 0, v62, s[58:59]
  v_cndmask_b32 v11, 0, v63, s[58:59]
  s_mov_b32 s58, 15728880
  s_mov_b32 s59, s58
  v_cndmask_b32 v12, 0, v60, s[58:59]
  v_cndmask_b32 v13, 0, v61, s[58:59]
  v_cndmask_b32 v14, 0, v62, s[58:59]
  v_cndmask_b32 v15, 0, v63, s[58:59]
  s_mov_b32 s58, 251662080
  s_mov_b32 s59, s58
  v_cndmask_b32 v16, 0, v60, s[58:59]
  v_cndmask_b32 v17, 0, v61, s[58:59]
  v_cndmask_b32 v18, 0, v62, s[58:59]
  v_cndmask_b32 v19, 0, v63, s[58:59]
  s_mov_b32 s58, 4026593280
  s_mov_b32 s59, s58
  v_cndmask_b32 v20, 0, v60, s[58:59]
  v_cndmask_b32 v21, 0, v61, s[58:59]
  v_cndmask_b32 v22, 0, v62, s[58:59]
  v_cndmask_b32 v23, 0, v63, s[58:59]
  v_mov_b32 v69, 1
  s_nop 1
  s_cmp_eq_u32 s3, 5
  s_cbranch_scc0 L_step
  s_waitcnt vmcnt(0)
  v_mfma_f32_16x16x32_bf16 v[28:31], a[0:3], v[8:11], 0
  v_mfma_f32_16x16x32_bf16 v[28:31], a[4:7], v[12:15], v[28:31]
  v_mfma_f32_16x16x32_bf16 v[28:31], a[8:11], v[16:19], v[28:31]
  v_mfma_f32_16x16x32_bf16 v[28:31], a[12:15], v[20:23], v[28:31]
  v_mfma_f32_16x16x32_bf16 v[32:35], a[16:19], v[8:11], 0
  v_mfma_f32_16x16x32_bf16 v[32:35], a[20:23], v[12:15], v[32:35]
  v_mfma_f32_16x16x32_bf16 v[32:35], a[24:27], v[16:19], v[32:35]
  v_mfma_f32_16x16x32_bf16 v[32:35], a[28:31], v[20:23], v[32:35]
  v_mfma_f32_16x16x32_bf16 v[36:39], a[32:35], v[8:11], 0
  v_mfma_f32_16x16x32_bf16 v[36:39], a[36:39], v[12:15], v[36:39]
  v_mfma_f32_16x16x32_bf16 v[36:39], a[40:43], v[16:19], v[36:39]
  v_mfma_f32_16x16x32_bf16 v[36:39], a[44:47], v[20:23], v[36:39]
  v_mfma_f32_16x16x32_bf16 v[40:43], a[48:51], v[8:11], 0
  v_mfma_f32_16x16x32_bf16 v[40:43], a[52:55], v[12:15], v[40:43]
  v_mfma_f32_16x16x32_bf16 v[40:43], a[56:59], v[16:19], v[40:43]
  v_mfma_f32_16x16x32_bf16 v[40:43], a[60:63], v[20:23], v[40:43]
  v_cndmask_b32 v65, v28, v33, s[52:53]
  v_cndmask_b32 v66, v30, v35, s[52:53]
  v_cndmask_b32 v67, v32, v29, s[52:53]
  v_cndmask_b32 v68, v34, v31, s[52:53]
  v_cndmask_b32 v60, v67, v68, s[54:55]
  v_cndmask_b32 v59, v65, v66, s[54:55]
  s_nop 1
  v_add_f32_dpp v63, v60, v59 quad_perm:[1,0,3,2] row_mask:0xf bank_mask:0xf
  v_cndmask_b32 v65, v36, v41, s[52:53]
  v_cndmask_b32 v66, v38, v43, s[52:53]
  v_cndmask_b32 v67, v40, v37, s[52:53]
  v_cndmask_b32 v68, v42, v39, s[52:53]
  v_cndmask_b32 v62, v67, v68, s[54:55]
  v_cndmask_b32 v61, v65, v66, s[54:55]
  s_nop 1
  v_add_f32_dpp v64, v62, v61 quad_perm:[1,0,3,2] row_mask:0xf bank_mask:0xf
  v_cndmask_b32 v60, v64, v63, s[54:55]
  v_cndmask_b32 v59, v63, v64, s[54:55]
  s_nop 1
  v_add_f32_dpp v56, v60, v59 quad_perm:[2,3,0,1] row_mask:0xf bank_mask:0xf
  v_cvt_pk_bf16_f32 v56, v56, v56
  v_lshlrev_b32 v56, 16, v56
  v_mul_f32 v56, 1035273459, v56
  v_cvt_pk_bf16_f32 v56, v56, v56
  v_lshlrev_b32 v56, 16, v56
  ds_write_b32 v70, v56 offset:1536
  v_mfma_f32_16x16x32_bf16 v[28:31], a[64:67], v[8:11], 0
  v_mfma_f32_16x16x32_bf16 v[28:31], a[68:71], v[12:15], v[28:31]
  v_mfma_f32_16x16x32_bf16 v[28:31], a[72:75], v[16:19], v[28:31]
  v_mfma_f32_16x16x32_bf16 v[28:31], a[76:79], v[20:23], v[28:31]
  v_mfma_f32_16x16x32_bf16 v[32:35], a[80:83], v[8:11], 0
  v_mfma_f32_16x16x32_bf16 v[32:35], a[84:87], v[12:15], v[32:35]
  v_mfma_f32_16x16x32_bf16 v[32:35], a[88:91], v[16:19], v[32:35]
  v_mfma_f32_16x16x32_bf16 v[32:35], a[92:95], v[20:23], v[32:35]
  v_mfma_f32_16x16x32_bf16 v[36:39], a[96:99], v[8:11], 0
  v_mfma_f32_16x16x32_bf16 v[36:39], a[100:103], v[12:15], v[36:39]
  v_mfma_f32_16x16x32_bf16 v[36:39], a[104:107], v[16:19], v[36:39]
  v_mfma_f32_16x16x32_bf16 v[36:39], a[108:111], v[20:23], v[36:39]
  v_mfma_f32_16x16x32_bf16 v[40:43], a[112:115], v[8:11], 0
  v_mfma_f32_16x16x32_bf16 v[40:43], a[116:119], v[12:15], v[40:43]
  v_mfma_f32_16x16x32_bf16 v[40:43], a[120:123], v[16:19], v[40:43]
  v_mfma_f32_16x16x32_bf16 v[40:43], a[124:127], v[20:23], v[40:43]
  v_cndmask_b32 v65, v28, v33, s[52:53]
  v_cndmask_b32 v66, v30, v35, s[52:53]
  v_cndmask_b32 v67, v32, v29, s[52:53]
  v_cndmask_b32 v68, v34, v31, s[52:53]
  v_cndmask_b32 v60, v67, v68, s[54:55]
  v_cndmask_b32 v59, v65, v66, s[54:55]
  s_nop 1
  v_add_f32_dpp v63, v60, v59 quad_perm:[1,0,3,2] row_mask:0xf bank_mask:0xf
  v_cndmask_b32 v65, v36, v41, s[52:53]
  v_cndmask_b32 v66, v38, v43, s[52:53]
  v_cndmask_b32 v67, v40, v37, s[52:53]
  v_cndmask_b32 v68, v42, v39, s[52:53]
  v_cndmask_b32 v62, v67, v68, s[54:55]
  v_cndmask_b32 v61, v65, v66, s[54:55]
  s_nop 1
  v_add_f32_dpp v64, v62, v61 quad_perm:[1,0,3,2] row_mask:0xf bank_mask:0xf
  v_cndmask_b32 v60, v64, v63, s[54:55]
  v_cndmask_b32 v59, v63, v64, s[54:55]
  s_nop 1
  v_add_f32_dpp v56, v60, v59 quad_perm:[2,3,0,1] row_mask:0xf bank_mask:0xf
  v_cvt_pk_bf16_f32 v56, v56, v56
  v_lshlrev_b32 v56, 16, v56
  v_mul_f32 v56, 1035273459, v56
  v_cvt_pk_bf16_f32 v56, v56, v56
  v_lshlrev_b32 v56, 16, v56
  ds_write_b32 v70, v56 offset:17920
  s_waitcnt lgkmcnt(0)
  ds_write_b32 v73, v69 offset:260
  s_mov_b32 s60, 0
  s_mov_b32 s61, 7296
  s_mov_b32 s62, -1
  s_lshl_b32 s68, s45, 20
  s_mov_b32 s69, 16
  s_mov_b32 s71, 0
  s_lshl_b32 s72, s49, 8
  s_add_u32 s72, s72, 53248
  s_lshl_b32 s73, s48, 2
  s_add_u32 s73, s73, s72
  v_and_b32 v94, 31, v0
  v_lshlrev_b32 v94, 2, v94
  v_mov_b32 v95, 4098
L_ctl:
  s_add_u32 s62, s62, 6
  s_lshr_b32 s58, s60, 0
  v_readlane_b32 s63, v90, s58
  v_readlane_b32 s64, v91, s58
  s_add_u32 s77, s60, 1
  s_lshl_b32 s74, s77, 12
  s_or_b32 s74, s74, s68
  s_lshl_b32 s58, s69, 6
  s_or_b32 s74, s74, s58
  s_or_b32 s58, s74, s71
  v_mov_b32 v62, s58
  s_and_b32 s75, s60, 0
  s_cmp_lt_u32 s48, 4
  s_cselect_b32 s75, s75, 1
  s_cmp_lg_u32 s75, 0
  s_cbranch_scc1 L_norep
  s_sub_u32 s76, s62, 2
  s_mov_b32 s70, 1600000
L_ctlm:
  s_sleep 1
  ds_read_b64 v[60:61], v73 offset:264
  s_waitcnt lgkmcnt(0)
  v_add_u32 v60, v60, v61
  s_nop 0
  v_readfirstlane_b32 s67, v60
  s_sub_u32 s70, s70, 1
  s_cmp_eq_u32 s70, 0
  s_cbranch_scc1 L_fin
  s_cmp_lt_u32 s67, s76
  s_cbranch_scc1 L_ctlm
  s_sub_u32 s76, s74, 4096
  s_mov_b32 s78, 1
  s_atomic_add s78, s[26:27], s63 glc
  s_waitcnt lgkmcnt(0)
  s_sub_u32 s78, s78, s64
  s_min_u32 s78, s78, 7
  s_or_b32 s71, s78, 8
  s_or_b32 s58, s76, s71
  v_mov_b32 v62, s58
  s_mov_b64 exec, 1
  buffer_store_dword v62, off, s[28:31], s73
  s_mov_b64 exec, -1
  s_or_b32 s58, s74, s71
  v_mov_b32 v62, s58
L_norep:
  s_mov_b32 s70, 1600000
L_ctlw:
  s_sleep 1
  ds_read_b64 v[60:61], v73 offset:264
  s_waitcnt lgkmcnt(0)
  v_add_u32 v60, v60, v61
  s_nop 0
  v_readfirstlane_b32 s67, v60
  s_sub_u32 s70, s70, 1
  s_cmp_eq_u32 s70, 0
  s_cbranch_scc1 L_fin
  s_cmp_lt_u32 s67, s62
  s_cbranch_scc1 L_ctlw
  s_mov_b64 exec, 1
  buffer_store_dword v62, off, s[28:31], s73
  s_mov_b64 exec, -1
  buffer_load_dword v63, v94, s[28:31], s72 offen sc1
  s_waitcnt vmcnt(0)
  v_bfe_u32 v64, v63, 12, 8
  v_subrev_u32 v64, s77, v64
  v_add_u32 v64, 3, v64
  v_med3_i32 v64, v64, 0, 7
  v_bfe_u32 v65, v63, 6, 6
  v_lshl_or_b32 v64, v65, 8, v64
  v_and_b32 v65, 7, v63
  v_lshl_or_b32 v64, v65, 19, v64
  v_bfe_u32 v65, v63, 3, 1
  v_lshl_or_b32 v64, v65, 27, v64
  v_xor_b32 v65, s68, v63
  v_lshrrev_b32 v65, 20, v65
  v_cmp_eq_u32 vcc, 0, v65
  s_nop 1
  v_cndmask_b32 v64, v95, v64, vcc
  s_nop 1
  v_add_u32_dpp v64, v64, v64 row_ror:8 row_mask:0xf bank_mask:0xf
  s_nop 1
  v_add_u32_dpp v64, v64, v64 row_ror:4 row_mask:0xf bank_mask:0xf
  s_nop 1
  v_add_u32_dpp v64, v64, v64 row_ror:2 row_mask:0xf bank_mask:0xf
  s_nop 1
  v_add_u32_dpp v64, v64, v64 row_ror:1 row_mask:0xf bank_mask:0xf
  s_nop 0
  v_readlane_b32 s58, v64, 0
  v_readlane_b32 s59, v64, 16
  s_nop 0
  s_add_u32 s58, s58, s59
  s_and_b32 s69, s58, 0xff
  s_sub_i32 s69, s69, 64
  s_max_i32 s69, s69, 0
  s_min_i32 s69, s69, 63
  s_bfe_u32 s65, s58, 720904
  s_lshl_b32 s66, s69, 5
  s_sub_i32 s65, s66, s65
  s_bfe_u32 s66, s58, 524307
  s_lshl_b32 s66, s66, 1
  s_lshr_b32 s59, s58, 27
  s_mul_i32 s59, s59, 7
  s_sub_i32 s66, s66, s59
  s_mul_i32 s58, s65, 9
  s_ashr_i32 s58, s58, 5
  s_cmp_lt_u32 s60, 4
  s_cselect_b32 s58, 0, s58
  s_add_i32 s61, s61, s58
  s_mul_i32 s58, s66, 3
  s_add_i32 s61, s61, s58
  s_max_i32 s61, s61, 0
  s_min_i32 s61, s61, 16384
  s_mul_i32 s58, s65, 297
  s_ashr_i32 s58, s58, 5
  s_add_i32 s58, s58, s61
  s_mul_i32 s59, s66, 188
  s_add_i32 s58, s58, s59
  s_ashr_i32 s58, s58, 6
  s_max_i32 s58, s58, 0
  s_min_i32 s58, s58, 256
  v_mov_b32 v60, s58
  v_mov_b32 v61, s58
  ds_write_b64 v73, v[60:61] offset:288
  s_add_u32 s60, s60, 1
  s_cmp_lt_u32 s60, 41
  s_cbranch_scc1 L_ctl
  s_branch L_fin
.p2align 6
L_step:
  s_mov_b32 s43, s60
  s_mov_b32 s44, s64
  s_waitcnt lgkmcnt(0)
  v_cmp_ge_u32 vcc, v121, v6
  v_mov_b32 v59, -18
  v_mov_b32 v60, 18
  v_cndmask_b32 v59, v59, v60, vcc
  v_add_u32 v79, v79, v59
  v_max_i32 v79, 0, v79
  v_min_i32 v79, 256, v79
  v_mov_b32 v56, v72
  v_readfirstlane_b32 s62, v79
  s_cmp_lg_u32 s69, 0
  s_cbranch_scc1 L_have
  s_nop 2
  s_call_b64 s[80:81], F_newrun
L_have:
  s_sub_u32 s69, s69, 1
  s_mov_b32 s60, s68
  s_mov_b32 s64, s71
  v_add_u32 v71, s71, v70
  v_add_u32 v6, 1, v6
  ds_read_b32 v72, v71
  ds_write_b32 v74, v6 offset:264
  ds_read_b32 v121, v58 offset:264
  s_add_u32 s71, s71, 256
  s_mul_i32 s62, s62, s65
  s_add_u32 s62, s62, s66
  s_add_u32 s66, s66, s67
  s_and_b32 s77, s77, 255
  s_add_u32 s77, s77, s62
  s_cmp_ge_u32 s43, 2
  s_cbranch_scc1 L_v
  s_cmp_lt_u32 s77, 256
  s_cbranch_scc1 L_k0
  s_cmp_lt_u32 s77, 512
  s_cbranch_scc1 L_k1
  s_cmp_lt_u32 s77, 768
  s_cbranch_scc1 L_k2
  s_cmp_lt_u32 s77, 1024
  s_cbranch_scc1 L_k3
  s_cmp_lt_u32 s77, 1280
  s_cbranch_scc1 L_k4
  s_cmp_lt_u32 s77, 1536
  s_cbranch_scc1 L_k5
  s_cmp_lt_u32 s77, 1792
  s_cbranch_scc1 L_k6
L_k7:
  s_waitcnt vmcnt(11)
  v_mfma_f32_16x16x32_bf16 v[28:31], a[0:3], v[8:11], 0
  buffer_load_dwordx4 a[0:3], v4, s[36:39], s74 offen offset:0 nt
  s_waitcnt vmcnt(12)
  v_mfma_f32_16x16x32_bf16 v[28:31], a[4:7], v[12:15], v[28:31]
  buffer_load_dwordx4 a[4:7], v4, s[36:39], s74 offen offset:1024 nt
  s_waitcnt vmcnt(11)
  v_mfma_f32_16x16x32_bf16 v[28:31], a[8:11], v[16:19], v[28:31]
  s_add_u32 s75, s74, 8192
  buffer_load_dwordx4 a[8:11], v4, s[36:39], s75 offen offset:0 nt
  s_waitcnt vmcnt(12)
  v_mfma_f32_16x16x32_bf16 v[28:31], a[12:15], v[20:23], v[28:31]
  buffer_load_dwordx4 a[12:15], v4, s[36:39], s75 offen offset:1024 nt
  s_waitcnt vmcnt(11)
  v_mfma_f32_16x16x32_bf16 v[32:35], a[16:19], v[8:11], 0
  buffer_load_dwordx4 a[16:19], v4, s[36:39], s74 offen offset:2048 nt
  s_waitcnt vmcnt(12)
  v_mfma_f32_16x16x32_bf16 v[32:35], a[20:23], v[12:15], v[32:35]
  buffer_load_dwordx4 a[20:23], v4, s[36:39], s74 offen offset:3072 nt
  s_waitcnt vmcnt(11)
  v_mfma_f32_16x16x32_bf16 v[32:35], a[24:27], v[16:19], v[32:35]
  s_add_u32 s75, s74, 8192
  buffer_load_dwordx4 a[24:27], v4, s[36:39], s75 offen offset:2048 nt
  s_waitcnt vmcnt(12)
  v_mfma_f32_16x16x32_bf16 v[32:35], a[28:31], v[20:23], v[32:35]
  buffer_load_dwordx4 a[28:31], v4, s[36:39], s75 offen offset:3072 nt
  s_waitcnt vmcnt(11)
  v_mfma_f32_16x16x32_bf16 v[36:39], a[32:35], v[8:11], 0
  s_add_u32 s75, s74, 16384
  buffer_load_dwordx4 a[32:35], v4, s[36:39], s75 offen offset:0 nt
  s_waitcnt vmcnt(12)
  v_mfma_f32_16x16x32_bf16 v[36:39], a[36:39], v[12:15], v[36:39]
  buffer_load_dwordx4 a[36:39], v4, s[36:39], s75 offen offset:1024 nt
  s_waitcnt vmcnt(11)
  v_mfma_f32_16x16x32_bf16 v[36:39], a[40:43], v[16:19], v[36:39]
  s_add_u32 s75, s74, 24576
  buffer_load_dwordx4 a[40:43], v4, s[36:39], s75 offen offset:0 nt
  s_waitcnt vmcnt(12)
  v_mfma_f32_16x16x32_bf16 v[36:39], a[44:47], v[20:23], v[36:39]
  buffer_load_dwordx4 a[44:47], v4, s[36:39], s75 offen offset:1024 nt
  s_waitcnt vmcnt(11)
  v_mfma_f32_16x16x32_bf16 v[40:43], a[48:51], v[8:11], 0
  s_add_u32 s75, s74, 16384
  buffer_load_dwordx4 a[48:51], v4, s[36:39], s75 offen offset:2048 nt
  s_waitcnt vmcnt(12)
  v_mfma_f32_16x16x32_bf16 v[40:43], a[52:55], v[12:15], v[40:43]
  buffer_load_dwordx4 a[52:55], v4, s[36:39], s75 offen offset:3072 nt
  s_waitcnt vmcnt(11)
  v_mfma_f32_16x16x32_bf16 v[40:43], a[56:59], v[16:19], v[40:43]
  s_add_u32 s75, s74, 24576
  buffer_load_dwordx4 a[56:59], v4, s[36:39], s75 offen offset:2048 nt
  s_waitcnt vmcnt(12)
  v_mfma_f32_16x16x32_bf16 v[40:43], a[60:63], v[20:23], v[40:43]
  buffer_load_dwordx4 a[60:63], v4, s[36:39], s75 offen offset:3072 nt
  s_mov_b32 s74, s73
  s_bfe_u32 s58, s76, 393216
  s_lshl_b32 s58, s58, 18
  s_add_u32 s74, s74, s58
  s_add_u32 s76, s76, 1
  ds_read_b32 v79, v74 offset:288
  s_nop 0
  s_branch L_kscore
L_k6:
  s_waitcnt vmcnt(11)
  v_mfma_f32_16x16x32_bf16 v[28:31], a[0:3], v[8:11], 0
  buffer_load_dwordx4 a[0:3], v4, s[36:39], s74 offen offset:0 nt
  s_waitcnt vmcnt(11)
  v_mfma_f32_16x16x32_bf16 v[28:31], a[4:7], v[12:15], v[28:31]
  buffer_load_dwordx4 a[4:7], v4, s[36:39], s74 offen offset:1024 nt
  s_waitcnt vmcnt(11)
  v_mfma_f32_16x16x32_bf16 v[28:31], a[8:11], v[16:19], v[28:31]
  s_add_u32 s75, s74, 8192
  buffer_load_dwordx4 a[8:11], v4, s[36:39], s75 offen offset:0 nt
  s_waitcnt vmcnt(11)
  v_mfma_f32_16x16x32_bf16 v[28:31], a[12:15], v[20:23], v[28:31]
  buffer_load_dwordx4 a[12:15], v4, s[36:39], s75 offen offset:1024 nt
  s_waitcnt vmcnt(11)
  v_mfma_f32_16x16x32_bf16 v[32:35], a[16:19], v[8:11], 0
  buffer_load_dwordx4 a[16:19], v4, s[36:39], s74 offen offset:2048 nt
  s_waitcnt vmcnt(11)
  v_mfma_f32_16x16x32_bf16 v[32:35], a[20:23], v[12:15], v[32:35]
  buffer_load_dwordx4 a[20:23], v4, s[36:39], s74 offen offset:3072 nt
  s_waitcnt vmcnt(11)
  v_mfma_f32_16x16x32_bf16 v[32:35], a[24:27], v[16:19], v[32:35]
  s_add_u32 s75, s74, 8192
  buffer_load_dwordx4 a[24:27], v4, s[36:39], s75 offen offset:2048 nt
  s_waitcnt vmcnt(11)
  v_mfma_f32_16x16x32_bf16 v[32:35], a[28:31], v[20:23], v[32:35]
  buffer_load_dwordx4 a[28:31], v4, s[36:39], s75 offen offset:3072 nt
  s_waitcnt vmcnt(11)
  v_mfma_f32_16x16x32_bf16 v[36:39], a[32:35], v[8:11], 0
  s_add_u32 s75, s74, 16384
  buffer_load_dwordx4 a[32:35], v4, s[36:39], s75 offen offset:0 nt
  s_waitcnt vmcnt(11)
  v_mfma_f32_16x16x32_bf16 v[36:39], a[36:39], v[12:15], v[36:39]
  buffer_load_dwordx4 a[36:39], v4, s[36:39], s75 offen offset:1024 nt
  s_waitcnt vmcnt(11)
  v_mfma_f32_16x16x32_bf16 v[36:39], a[40:43], v[16:19], v[36:39]
  s_add_u32 s75, s74, 24576
  buffer_load_dwordx4 a[40:43], v4, s[36:39], s75 offen offset:0 nt
  s_waitcnt vmcnt(11)
  v_mfma_f32_16x16x32_bf16 v[36:39], a[44:47], v[20:23], v[36:39]
  buffer_load_dwordx4 a[44:47], v4, s[36:39], s75 offen offset:1024 nt
  s_waitcnt vmcnt(11)
  v_mfma_f32_16x16x32_bf16 v[40:43], a[48:51], v[8:11], 0
  s_add_u32 s75, s74, 16384
  buffer_load_dwordx4 a[48:51], v4, s[36:39], s75 offen offset:2048 nt
  s_waitcnt vmcnt(11)
  v_mfma_f32_16x16x32_bf16 v[40:43], a[52:55], v[12:15], v[40:43]
  buffer_load_dwordx4 a[52:55], v4, s[36:39], s75 offen offset:3072 nt
  s_waitcnt vmcnt(11)
  v_mfma_f32_16x16x32_bf16 v[40:43], a[56:59], v[16:19], v[40:43]
  s_add_u32 s75, s74, 24576
  buffer_load_dwordx4 a[56:59], v4, s[36:39], s75 offen offset:2048 nt
  s_waitcnt vmcnt(11)
  v_mfma_f32_16x16x32_bf16 v[40:43], a[60:63], v[20:23], v[40:43]
  buffer_load_dwordx4 a[60:63], v4, s[36:39], s75 offen offset:3072 nt
  s_mov_b32 s74, s73
  s_bfe_u32 s58, s76, 393216
  s_lshl_b32 s58, s58, 18
  s_add_u32 s74, s74, s58
  s_add_u32 s76, s76, 1
  ds_read_b32 v79, v74 offset:288
  s_nop 0
  s_branch L_kscore
L_k5:
  s_waitcnt vmcnt(10)
  v_mfma_f32_16x16x32_bf16 v[28:31], a[0:3], v[8:11], 0
  buffer_load_dwordx4 a[0:3], v4, s[36:39], s74 offen offset:0 nt
  s_waitcnt vmcnt(11)
  v_mfma_f32_16x16x32_bf16 v[28:31], a[4:7], v[12:15], v[28:31]
  buffer_load_dwordx4 a[4:7], v4, s[36:39], s74 offen offset:1024 nt
  s_waitcnt vmcnt(10)
  v_mfma_f32_16x16x32_bf16 v[28:31], a[8:11], v[16:19], v[28:31]
  s_add_u32 s75, s74, 8192
  buffer_load_dwordx4 a[8:11], v4, s[36:39], s75 offen offset:0 nt
  s_waitcnt vmcnt(11)
  v_mfma_f32_16x16x32_bf16 v[28:31], a[12:15], v[20:23], v[28:31]
  buffer_load_dwordx4 a[12:15], v4, s[36:39], s75 offen offset:1024 nt
  s_waitcnt vmcnt(10)
  v_mfma_f32_16x16x32_bf16 v[32:35], a[16:19], v[8:11], 0
  buffer_load_dwordx4 a[16:19], v4, s[36:39], s74 offen offset:2048 nt
  s_waitcnt vmcnt(11)
  v_mfma_f32_16x16x32_bf16 v[32:35], a[20:23], v[12:15], v[32:35]
  buffer_load_dwordx4 a[20:23], v4, s[36:39], s74 offen offset:3072 nt
  s_waitcnt vmcnt(10)
  v_mfma_f32_16x16x32_bf16 v[32:35], a[24:27], v[16:19], v[32:35]
  s_add_u32 s75, s74, 8192
  buffer_load_dwordx4 a[24:27], v4, s[36:39], s75 offen offset:2048 nt
  s_waitcnt vmcnt(11)
  v_mfma_f32_16x16x32_bf16 v[32:35], a[28:31], v[20:23], v[32:35]
  buffer_load_dwordx4 a[28:31], v4, s[36:39], s75 offen offset:3072 nt
  s_waitcnt vmcnt(10)
  v_mfma_f32_16x16x32_bf16 v[36:39], a[32:35], v[8:11], 0
  s_add_u32 s75, s74, 16384
  buffer_load_dwordx4 a[32:35], v4, s[36:39], s75 offen offset:0 nt
  s_waitcnt vmcnt(11)
  v_mfma_f32_16x16x32_bf16 v[36:39], a[36:39], v[12:15], v[36:39]
  buffer_load_dwordx4 a[36:39], v4, s[36:39], s75 offen offset:1024 nt
  s_waitcnt vmcnt(10)
  v_mfma_f32_16x16x32_bf16 v[36:39], a[40:43], v[16:19], v[36:39]
  s_add_u32 s75, s74, 24576
  buffer_load_dwordx4 a[40:43], v4, s[36:39], s75 offen offset:0 nt
  s_waitcnt vmcnt(11)
  v_mfma_f32_16x16x32_bf16 v[36:39], a[44:47], v[20:23], v[36:39]
  buffer_load_dwordx4 a[44:47], v4, s[36:39], s75 offen offset:1024 nt
  s_waitcnt vmcnt(10)
  v_mfma_f32_16x16x32_bf16 v[40:43], a[48:51], v[8:11], 0
  s_add_u32 s75, s74, 16384
  buffer_load_dwordx4 a[48:51], v4, s[36:39], s75 offen offset:2048 nt
  s_waitcnt vmcnt(11)
  v_mfma_f32_16x16x32_bf16 v[40:43], a[52:55], v[12:15], v[40:43]
  buffer_load_dwordx4 a[52:55], v4, s[36:39], s75 offen offset:3072 nt
  s_waitcnt vmcnt(10)
  v_mfma_f32_16x16x32_bf16 v[40:43], a[56:59], v[16:19], v[40:43]
  s_add_u32 s75, s74, 24576
  buffer_load_dwordx4 a[56:59], v4, s[36:39], s75 offen offset:2048 nt
  s_waitcnt vmcnt(11)
  v_mfma_f32_16x16x32_bf16 v[40:43], a[60:63], v[20:23], v[40:43]
  buffer_load_dwordx4 a[60:63], v4, s[36:39], s75 offen offset:3072 nt
  s_mov_b32 s74, s73
  s_bfe_u32 s58, s76, 393216
  s_lshl_b32 s58, s58, 18
  s_add_u32 s74, s74, s58
  s_add_u32 s76, s76, 1
  ds_read_b32 v79, v74 offset:288
  s_nop 0
  s_branch L_kscore
L_k4:
  s_waitcnt vmcnt(10)
  v_mfma_f32_16x16x32_bf16 v[28:31], a[0:3], v[8:11], 0
  buffer_load_dwordx4 a[0:3], v4, s[36:39], s74 offen offset:0 nt
  s_waitcnt vmcnt(10)
  v_mfma_f32_16x16x32_bf16 v[28:31], a[4:7], v[12:15], v[28:31]
  buffer_load_dwordx4 a[4:7], v4, s[36:39], s74 offen offset:1024 nt
  s_waitcnt vmcnt(10)
  v_mfma_f32_16x16x32_bf16 v[28:31], a[8:11], v[16:19], v[28:31]
  s_add_u32 s75, s74, 8192
  buffer_load_dwordx4 a[8:11], v4, s[36:39], s75 offen offset:0 nt
  s_waitcnt vmcnt(10)
  v_mfma_f32_16x16x32_bf16 v[28:31], a[12:15], v[20:23], v[28:31]
  buffer_load_dwordx4 a[12:15], v4, s[36:39], s75 offen offset:1024 nt
  s_waitcnt vmcnt(10)
  v_mfma_f32_16x16x32_bf16 v[32:35], a[16:19], v[8:11], 0
  buffer_load_dwordx4 a[16:19], v4, s[36:39], s74 offen offset:2048 nt
  s_waitcnt vmcnt(10)
  v_mfma_f32_16x16x32_bf16 v[32:35], a[20:23], v[12:15], v[32:35]
  buffer_load_dwordx4 a[20:23], v4, s[36:39], s74 offen offset:3072 nt
  s_waitcnt vmcnt(10)
  v_mfma_f32_16x16x32_bf16 v[32:35], a[24:27], v[16:19], v[32:35]
  s_add_u32 s75, s74, 8192
  buffer_load_dwordx4 a[24:27], v4, s[36:39], s75 offen offset:2048 nt
  s_waitcnt vmcnt(10)
  v_mfma_f32_16x16x32_bf16 v[32:35], a[28:31], v[20:23], v[32:35]
  buffer_load_dwordx4 a[28:31], v4, s[36:39], s75 offen offset:3072 nt
  s_waitcnt vmcnt(10)
  v_mfma_f32_16x16x32_bf16 v[36:39], a[32:35], v[8:11], 0
  s_add_u32 s75, s74, 16384
  buffer_load_dwordx4 a[32:35], v4, s[36:39], s75 offen offset:0 nt
  s_waitcnt vmcnt(10)
  v_mfma_f32_16x16x32_bf16 v[36:39], a[36:39], v[12:15], v[36:39]
  buffer_load_dwordx4 a[36:39], v4, s[36:39], s75 offen offset:1024 nt
  s_waitcnt vmcnt(10)
  v_mfma_f32_16x16x32_bf16 v[36:39], a[40:43], v[16:19], v[36:39]
  s_add_u32 s75, s74, 24576
  buffer_load_dwordx4 a[40:43], v4, s[36:39], s75 offen offset:0 nt
  s_waitcnt vmcnt(10)
  v_mfma_f32_16x16x32_bf16 v[36:39], a[44:47], v[20:23], v[36:39]
  buffer_load_dwordx4 a[44:47], v4, s[36:39], s75 offen offset:1024 nt
  s_waitcnt vmcnt(10)
  v_mfma_f32_16x16x32_bf16 v[40:43], a[48:51], v[8:11], 0
  s_add_u32 s75, s74, 16384
  buffer_load_dwordx4 a[48:51], v4, s[36:39], s75 offen offset:2048 nt
  s_waitcnt vmcnt(10)
  v_mfma_f32_16x16x32_bf16 v[40:43], a[52:55], v[12:15], v[40:43]
  buffer_load_dwordx4 a[52:55], v4, s[36:39], s75 offen offset:3072 nt
  s_waitcnt vmcnt(10)
  v_mfma_f32_16x16x32_bf16 v[40:43], a[56:59], v[16:19], v[40:43]
  s_add_u32 s75, s74, 24576
  buffer_load_dwordx4 a[56:59], v4, s[36:39], s75 offen offset:2048 nt
  s_waitcnt vmcnt(10)
  v_mfma_f32_16x16x32_bf16 v[40:43], a[60:63], v[20:23], v[40:43]
  buffer_load_dwordx4 a[60:63], v4, s[36:39], s75 offen offset:3072 nt
  s_mov_b32 s74, s73
  s_bfe_u32 s58, s76, 393216
  s_lshl_b32 s58, s58, 18
  s_add_u32 s74, s74, s58
  s_add_u32 s76, s76, 1
  ds_read_b32 v79, v74 offset:288
  s_nop 0
  s_branch L_kscore
L_k3:
  s_waitcnt vmcnt(9)
  v_mfma_f32_16x16x32_bf16 v[28:31], a[0:3], v[8:11], 0
  buffer_load_dwordx4 a[0:3], v4, s[36:39], s74 offen offset:0 nt
  s_waitcnt vmcnt(10)
  v_mfma_f32_16x16x32_bf16 v[28:31], a[4:7], v[12:15], v[28:31]
  buffer_load_dwordx4 a[4:7], v4, s[36:39], s74 offen offset:1024 nt
  s_waitcnt vmcnt(9)
  v_mfma_f32_16x16x32_bf16 v[28:31], a[8:11], v[16:19], v[28:31]
  s_add_u32 s75, s74, 8192
  buffer_load_dwordx4 a[8:11], v4, s[36:39], s75 offen offset:0 nt
  s_waitcnt vmcnt(10)
  v_mfma_f32_16x16x32_bf16 v[28:31], a[12:15], v[20:23], v[28:31]
  buffer_load_dwordx4 a[12:15], v4, s[36:39], s75 offen offset:1024 nt
  s_waitcnt vmcnt(9)
  v_mfma_f32_16x16x32_bf16 v[32:35], a[16:19], v[8:11], 0
  buffer_load_dwordx4 a[16:19], v4, s[36:39], s74 offen offset:2048 nt
  s_waitcnt vmcnt(10)
  v_mfma_f32_16x16x32_bf16 v[32:35], a[20:23], v[12:15], v[32:35]
  buffer_load_dwordx4 a[20:23], v4, s[36:39], s74 offen offset:3072 nt
  s_waitcnt vmcnt(9)
  v_mfma_f32_16x16x32_bf16 v[32:35], a[24:27], v[16:19], v[32:35]
  s_add_u32 s75, s74, 8192
  buffer_load_dwordx4 a[24:27], v4, s[36:39], s75 offen offset:2048 nt
  s_waitcnt vmcnt(10)
  v_mfma_f32_16x16x32_bf16 v[32:35], a[28:31], v[20:23], v[32:35]
  buffer_load_dwordx4 a[28:31], v4, s[36:39], s75 offen offset:3072 nt
  s_waitcnt vmcnt(9)
  v_mfma_f32_16x16x32_bf16 v[36:39], a[32:35], v[8:11], 0
  s_add_u32 s75, s74, 16384
  buffer_load_dwordx4 a[32:35], v4, s[36:39], s75 offen offset:0 nt
  s_waitcnt vmcnt(10)
  v_mfma_f32_16x16x32_bf16 v[36:39], a[36:39], v[12:15], v[36:39]
  buffer_load_dwordx4 a[36:39], v4, s[36:39], s75 offen offset:1024 nt
  s_waitcnt vmcnt(9)
  v_mfma_f32_16x16x32_bf16 v[36:39], a[40:43], v[16:19], v[36:39]
  s_add_u32 s75, s74, 24576
  buffer_load_dwordx4 a[40:43], v4, s[36:39], s75 offen offset:0 nt
  s_waitcnt vmcnt(10)
  v_mfma_f32_16x16x32_bf16 v[36:39], a[44:47], v[20:23], v[36:39]
  buffer_load_dwordx4 a[44:47], v4, s[36:39], s75 offen offset:1024 nt
  s_waitcnt vmcnt(9)
  v_mfma_f32_16x16x32_bf16 v[40:43], a[48:51], v[8:11], 0
  s_add_u32 s75, s74, 16384
  buffer_load_dwordx4 a[48:51], v4, s[36:39], s75 offen offset:2048 nt
  s_waitcnt vmcnt(10)
  v_mfma_f32_16x16x32_bf16 v[40:43], a[52:55], v[12:15], v[40:43]
  buffer_load_dwordx4 a[52:55], v4, s[36:39], s75 offen offset:3072 nt
  s_waitcnt vmcnt(9)
  v_mfma_f32_16x16x32_bf16 v[40:43], a[56:59], v[16:19], v[40:43]
  s_add_u32 s75, s74, 24576
  buffer_load_dwordx4 a[56:59], v4, s[36:39], s75 offen offset:2048 nt
  s_waitcnt vmcnt(10)
  v_mfma_f32_16x16x32_bf16 v[40:43], a[60:63], v[20:23], v[40:43]
  buffer_load_dwordx4 a[60:63], v4, s[36:39], s75 offen offset:3072 nt
  s_mov_b32 s74, s73
  s_bfe_u32 s58, s76, 393216
  s_lshl_b32 s58, s58, 18
  s_add_u32 s74, s74, s58
  s_add_u32 s76, s76, 1
  ds_read_b32 v79, v74 offset:288
  s_nop 0
  s_branch L_kscore
L_k2:
  s_waitcnt vmcnt(9)
  v_mfma_f32_16x16x32_bf16 v[28:31], a[0:3], v[8:11], 0
  buffer_load_dwordx4 a[0:3], v4, s[36:39], s74 offen offset:0 nt
  s_waitcnt vmcnt(9)
  v_mfma_f32_16x16x32_bf16 v[28:31], a[4:7], v[12:15], v[28:31]
  buffer_load_dwordx4 a[4:7], v4, s[36:39], s74 offen offset:1024 nt
  s_waitcnt vmcnt(9)
  v_mfma_f32_16x16x32_bf16 v[28:31], a[8:11], v[16:19], v[28:31]
  s_add_u32 s75, s74, 8192
  buffer_load_dwordx4 a[8:11], v4, s[36:39], s75 offen offset:0 nt
  s_waitcnt vmcnt(9)
  v_mfma_f32_16x16x32_bf16 v[28:31], a[12:15], v[20:23], v[28:31]
  buffer_load_dwordx4 a[12:15], v4, s[36:39], s75 offen offset:1024 nt
  s_waitcnt vmcnt(9)
  v_mfma_f32_16x16x32_bf16 v[32:35], a[16:19], v[8:11], 0
  buffer_load_dwordx4 a[16:19], v4, s[36:39], s74 offen offset:2048 nt
  s_waitcnt vmcnt(9)
  v_mfma_f32_16x16x32_bf16 v[32:35], a[20:23], v[12:15], v[32:35]
  buffer_load_dwordx4 a[20:23], v4, s[36:39], s74 offen offset:3072 nt
  s_waitcnt vmcnt(9)
  v_mfma_f32_16x16x32_bf16 v[32:35], a[24:27], v[16:19], v[32:35]
  s_add_u32 s75, s74, 8192
  buffer_load_dwordx4 a[24:27], v4, s[36:39], s75 offen offset:2048 nt
  s_waitcnt vmcnt(9)
  v_mfma_f32_16x16x32_bf16 v[32:35], a[28:31], v[20:23], v[32:35]
  buffer_load_dwordx4 a[28:31], v4, s[36:39], s75 offen offset:3072 nt
  s_waitcnt vmcnt(9)
  v_mfma_f32_16x16x32_bf16 v[36:39], a[32:35], v[8:11], 0
  s_add_u32 s75, s74, 16384
  buffer_load_dwordx4 a[32:35], v4, s[36:39], s75 offen offset:0 nt
  s_waitcnt vmcnt(9)
  v_mfma_f32_16x16x32_bf16 v[36:39], a[36:39], v[12:15], v[36:39]
  buffer_load_dwordx4 a[36:39], v4, s[36:39], s75 offen offset:1024 nt
  s_waitcnt vmcnt(9)
  v_mfma_f32_16x16x32_bf16 v[36:39], a[40:43], v[16:19], v[36:39]
  s_add_u32 s75, s74, 24576
  buffer_load_dwordx4 a[40:43], v4, s[36:39], s75 offen offset:0 nt
  s_waitcnt vmcnt(9)
  v_mfma_f32_16x16x32_bf16 v[36:39], a[44:47], v[20:23], v[36:39]
  buffer_load_dwordx4 a[44:47], v4, s[36:39], s75 offen offset:1024 nt
  s_waitcnt vmcnt(9)
  v_mfma_f32_16x16x32_bf16 v[40:43], a[48:51], v[8:11], 0
  s_add_u32 s75, s74, 16384
  buffer_load_dwordx4 a[48:51], v4, s[36:39], s75 offen offset:2048 nt
  s_waitcnt vmcnt(9)
  v_mfma_f32_16x16x32_bf16 v[40:43], a[52:55], v[12:15], v[40:43]
  buffer_load_dwordx4 a[52:55], v4, s[36:39], s75 offen offset:3072 nt
  s_waitcnt vmcnt(9)
  v_mfma_f32_16x16x32_bf16 v[40:43], a[56:59], v[16:19], v[40:43]
  s_add_u32 s75, s74, 24576
  buffer_load_dwordx4 a[56:59], v4, s[36:39], s75 offen offset:2048 nt
  s_waitcnt vmcnt(9)
  v_mfma_f32_16x16x32_bf16 v[40:43], a[60:63], v[20:23], v[40:43]
  buffer_load_dwordx4 a[60:63], v4, s[36:39], s75 offen offset:3072 nt
  s_mov_b32 s74, s73
  s_bfe_u32 s58, s76, 393216
  s_lshl_b32 s58, s58, 18
  s_add_u32 s74, s74, s58
  s_add_u32 s76, s76, 1
  ds_read_b32 v79, v74 offset:288
  s_nop 0
  s_branch L_kscore
L_k1:
  s_waitcnt vmcnt(8)
  v_mfma_f32_16x16x32_bf16 v[28:31], a[0:3], v[8:11], 0
  buffer_load_dwordx4 a[0:3], v4, s[36:39], s74 offen offset:0 nt
  s_waitcnt vmcnt(9)
  v_mfma_f32_16x16x32_bf16 v[28:31], a[4:7], v[12:15], v[28:31]
  buffer_load_dwordx4 a[4:7], v4, s[36:39], s74 offen offset:1024 nt
  s_waitcnt vmcnt(8)
  v_mfma_f32_16x16x32_bf16 v[28:31], a[8:11], v[16:19], v[28:31]
  s_add_u32 s75, s74, 8192
  buffer_load_dwordx4 a[8:11], v4, s[36:39], s75 offen offset:0 nt
  s_waitcnt vmcnt(9)
  v_mfma_f32_16x16x32_bf16 v[28:31], a[12:15], v[20:23], v[28:31]
  buffer_load_dwordx4 a[12:15], v4, s[36:39], s75 offen offset:1024 nt
  s_waitcnt vmcnt(8)
  v_mfma_f32_16x16x32_bf16 v[32:35], a[16:19], v[8:11], 0
  buffer_load_dwordx4 a[16:19], v4, s[36:39], s74 offen offset:2048 nt
  s_waitcnt vmcnt(9)
  v_mfma_f32_16x16x32_bf16 v[32:35], a[20:23], v[12:15], v[32:35]
  buffer_load_dwordx4 a[20:23], v4, s[36:39], s74 offen offset:3072 nt
  s_waitcnt vmcnt(8)
  v_mfma_f32_16x16x32_bf16 v[32:35], a[24:27], v[16:19], v[32:35]
  s_add_u32 s75, s74, 8192
  buffer_load_dwordx4 a[24:27], v4, s[36:39], s75 offen offset:2048 nt
  s_waitcnt vmcnt(9)
  v_mfma_f32_16x16x32_bf16 v[32:35], a[28:31], v[20:23], v[32:35]
  buffer_load_dwordx4 a[28:31], v4, s[36:39], s75 offen offset:3072 nt
  s_waitcnt vmcnt(8)
  v_mfma_f32_16x16x32_bf16 v[36:39], a[32:35], v[8:11], 0
  s_add_u32 s75, s74, 16384
  buffer_load_dwordx4 a[32:35], v4, s[36:39], s75 offen offset:0 nt
  s_waitcnt vmcnt(9)
  v_mfma_f32_16x16x32_bf16 v[36:39], a[36:39], v[12:15], v[36:39]
  buffer_load_dwordx4 a[36:39], v4, s[36:39], s75 offen offset:1024 nt
  s_waitcnt vmcnt(8)
  v_mfma_f32_16x16x32_bf16 v[36:39], a[40:43], v[16:19], v[36:39]
  s_add_u32 s75, s74, 24576
  buffer_load_dwordx4 a[40:43], v4, s[36:39], s75 offen offset:0 nt
  s_waitcnt vmcnt(9)
  v_mfma_f32_16x16x32_bf16 v[36:39], a[44:47], v[20:23], v[36:39]
  buffer_load_dwordx4 a[44:47], v4, s[36:39], s75 offen offset:1024 nt
  s_waitcnt vmcnt(8)
  v_mfma_f32_16x16x32_bf16 v[40:43], a[48:51], v[8:11], 0
  s_add_u32 s75, s74, 16384
  buffer_load_dwordx4 a[48:51], v4, s[36:39], s75 offen offset:2048 nt
  s_waitcnt vmcnt(9)
  v_mfma_f32_16x16x32_bf16 v[40:43], a[52:55], v[12:15], v[40:43]
  buffer_load_dwordx4 a[52:55], v4, s[36:39], s75 offen offset:3072 nt
  s_waitcnt vmcnt(8)
  v_mfma_f32_16x16x32_bf16 v[40:43], a[56:59], v[16:19], v[40:43]
  s_add_u32 s75, s74, 24576
  buffer_load_dwordx4 a[56:59], v4, s[36:39], s75 offen offset:2048 nt
  s_waitcnt vmcnt(9)
  v_mfma_f32_16x16x32_bf16 v[40:43], a[60:63], v[20:23], v[40:43]
  buffer_load_dwordx4 a[60:63], v4, s[36:39], s75 offen offset:3072 nt
  s_mov_b32 s74, s73
  s_bfe_u32 s58, s76, 393216
  s_lshl_b32 s58, s58, 18
  s_add_u32 s74, s74, s58
  s_add_u32 s76, s76, 1
  ds_read_b32 v79, v74 offset:288
  s_nop 0
  s_branch L_kscore
L_k0:
  s_waitcnt vmcnt(8)
  v_mfma_f32_16x16x32_bf16 v[28:31], a[0:3], v[8:11], 0
  buffer_load_dwordx4 a[0:3], v4, s[36:39], s74 offen offset:0 nt
  s_waitcnt vmcnt(8)
  v_mfma_f32_16x16x32_bf16 v[28:31], a[4:7], v[12:15], v[28:31]
  buffer_load_dwordx4 a[4:7], v4, s[36:39], s74 offen offset:1024 nt
  s_waitcnt vmcnt(8)
  v_mfma_f32_16x16x32_bf16 v[28:31], a[8:11], v[16:19], v[28:31]
  s_add_u32 s75, s74, 8192
  buffer_load_dwordx4 a[8:11], v4, s[36:39], s75 offen offset:0 nt
  s_waitcnt vmcnt(8)
  v_mfma_f32_16x16x32_bf16 v[28:31], a[12:15], v[20:23], v[28:31]
  buffer_load_dwordx4 a[12:15], v4, s[36:39], s75 offen offset:1024 nt
  s_waitcnt vmcnt(8)
  v_mfma_f32_16x16x32_bf16 v[32:35], a[16:19], v[8:11], 0
  buffer_load_dwordx4 a[16:19], v4, s[36:39], s74 offen offset:2048 nt
  s_waitcnt vmcnt(8)
  v_mfma_f32_16x16x32_bf16 v[32:35], a[20:23], v[12:15], v[32:35]
  buffer_load_dwordx4 a[20:23], v4, s[36:39], s74 offen offset:3072 nt
  s_waitcnt vmcnt(8)
  v_mfma_f32_16x16x32_bf16 v[32:35], a[24:27], v[16:19], v[32:35]
  s_add_u32 s75, s74, 8192
  buffer_load_dwordx4 a[24:27], v4, s[36:39], s75 offen offset:2048 nt
  s_waitcnt vmcnt(8)
  v_mfma_f32_16x16x32_bf16 v[32:35], a[28:31], v[20:23], v[32:35]
  buffer_load_dwordx4 a[28:31], v4, s[36:39], s75 offen offset:3072 nt
  s_waitcnt vmcnt(8)
  v_mfma_f32_16x16x32_bf16 v[36:39], a[32:35], v[8:11], 0
  s_add_u32 s75, s74, 16384
  buffer_load_dwordx4 a[32:35], v4, s[36:39], s75 offen offset:0 nt
  s_waitcnt vmcnt(8)
  v_mfma_f32_16x16x32_bf16 v[36:39], a[36:39], v[12:15], v[36:39]
  buffer_load_dwordx4 a[36:39], v4, s[36:39], s75 offen offset:1024 nt
  s_waitcnt vmcnt(8)
  v_mfma_f32_16x16x32_bf16 v[36:39], a[40:43], v[16:19], v[36:39]
  s_add_u32 s75, s74, 24576
  buffer_load_dwordx4 a[40:43], v4, s[36:39], s75 offen offset:0 nt
  s_waitcnt vmcnt(8)
  v_mfma_f32_16x16x32_bf16 v[36:39], a[44:47], v[20:23], v[36:39]
  buffer_load_dwordx4 a[44:47], v4, s[36:39], s75 offen offset:1024 nt
  s_waitcnt vmcnt(8)
  v_mfma_f32_16x16x32_bf16 v[40:43], a[48:51], v[8:11], 0
  s_add_u32 s75, s74, 16384
  buffer_load_dwordx4 a[48:51], v4, s[36:39], s75 offen offset:2048 nt
  s_waitcnt vmcnt(8)
  v_mfma_f32_16x16x32_bf16 v[40:43], a[52:55], v[12:15], v[40:43]
  buffer_load_dwordx4 a[52:55], v4, s[36:39], s75 offen offset:3072 nt
  s_waitcnt vmcnt(8)
  v_mfma_f32_16x16x32_bf16 v[40:43], a[56:59], v[16:19], v[40:43]
  s_add_u32 s75, s74, 24576
  buffer_load_dwordx4 a[56:59], v4, s[36:39], s75 offen offset:2048 nt
  s_waitcnt vmcnt(8)
  v_mfma_f32_16x16x32_bf16 v[40:43], a[60:63], v[20:23], v[40:43]
  buffer_load_dwordx4 a[60:63], v4, s[36:39], s75 offen offset:3072 nt
  s_mov_b32 s74, s73
  s_bfe_u32 s58, s76, 393216
  s_lshl_b32 s58, s58, 18
  s_add_u32 s74, s74, s58
  s_add_u32 s76, s76, 1
  ds_read_b32 v79, v74 offset:288
L_kscore:
  v_cndmask_b32 v65, v28, v33, s[52:53]
  v_cndmask_b32 v66, v30, v35, s[52:53]
  v_cndmask_b32 v67, v32, v29, s[52:53]
  v_cndmask_b32 v68, v34, v31, s[52:53]
  v_cndmask_b32 v60, v67, v68, s[54:55]
  v_cndmask_b32 v59, v65, v66, s[54:55]
  s_nop 1
  v_add_f32_dpp v63, v60, v59 quad_perm:[1,0,3,2] row_mask:0xf bank_mask:0xf
  v_cndmask_b32 v65, v36, v41, s[52:53]
  v_cndmask_b32 v66, v38, v43, s[52:53]
  v_cndmask_b32 v67, v40, v37, s[52:53]
  v_cndmask_b32 v68, v42, v39, s[52:53]
  v_cndmask_b32 v62, v67, v68, s[54:55]
  v_cndmask_b32 v61, v65, v66, s[54:55]
  s_nop 1
  v_add_f32_dpp v64, v62, v61 quad_perm:[1,0,3,2] row_mask:0xf bank_mask:0xf
  v_cndmask_b32 v60, v64, v63, s[54:55]
  v_cndmask_b32 v59, v63, v64, s[54:55]
  s_nop 1
  v_add_f32_dpp v56, v60, v59 quad_perm:[2,3,0,1] row_mask:0xf bank_mask:0xf
  v_cvt_pk_bf16_f32 v56, v56, v56
  v_lshlrev_b32 v56, 16, v56
  v_mul_f32 v56, 1035273459, v56
  v_cvt_pk_bf16_f32 v56, v56, v56
  v_lshlrev_b32 v56, 16, v56
  v_add_u32 v71, s44, v70
  ds_write_b32 v71, v56
  s_cmp_eq_u32 s61, 0
  s_cbranch_scc1 L_step
  s_mov_b32 s61, 0
  s_mov_b32 s44, s46
  v_mfma_f32_16x16x32_bf16 v[28:31], a[64:67], v[8:11], 0
  v_mfma_f32_16x16x32_bf16 v[28:31], a[68:71], v[12:15], v[28:31]
  v_mfma_f32_16x16x32_bf16 v[28:31], a[72:75], v[16:19], v[28:31]
  v_mfma_f32_16x16x32_bf16 v[28:31], a[76:79], v[20:23], v[28:31]
  v_mfma_f32_16x16x32_bf16 v[32:35], a[80:83], v[8:11], 0
  v_mfma_f32_16x16x32_bf16 v[32:35], a[84:87], v[12:15], v[32:35]
  v_mfma_f32_16x16x32_bf16 v[32:35], a[88:91], v[16:19], v[32:35]
  v_mfma_f32_16x16x32_bf16 v[32:35], a[92:95], v[20:23], v[32:35]
  v_mfma_f32_16x16x32_bf16 v[36:39], a[96:99], v[8:11], 0
  v_mfma_f32_16x16x32_bf16 v[36:39], a[100:103], v[12:15], v[36:39]
  v_mfma_f32_16x16x32_bf16 v[36:39], a[104:107], v[16:19], v[36:39]
  v_mfma_f32_16x16x32_bf16 v[36:39], a[108:111], v[20:23], v[36:39]
  v_mfma_f32_16x16x32_bf16 v[40:43], a[112:115], v[8:11], 0
  v_mfma_f32_16x16x32_bf16 v[40:43], a[116:119], v[12:15], v[40:43]
  v_mfma_f32_16x16x32_bf16 v[40:43], a[120:123], v[16:19], v[40:43]
  v_mfma_f32_16x16x32_bf16 v[40:43], a[124:127], v[20:23], v[40:43]
  s_nop 7
  s_branch L_kscore
L_v:
  v_cmp_gt_f32 vcc, v56, v7
  s_cbranch_vccz L_nomax
  s_nop 3
  s_call_b64 s[80:81], F_update
L_nomax:
  v_sub_f32 v59, v56, v7
  v_mul_f32 v59, 1069066811, v59
  v_exp_f32 v59, v59
  s_nop 0
  v_cvt_pk_bf16_f32 v57, v59, v59
  s_nop 1
  s_cmp_eq_u32 s60, 4
  s_cbranch_scc1 L_vlast
  s_cmp_lt_u32 s77, 256
  s_cbranch_scc1 L_v0
  s_cmp_lt_u32 s77, 512
  s_cbranch_scc1 L_v1
  s_cmp_lt_u32 s77, 768
  s_cbranch_scc1 L_v2
  s_cmp_lt_u32 s77, 1024
  s_cbranch_scc1 L_v3
  s_cmp_lt_u32 s77, 1280
  s_cbranch_scc1 L_v4
  s_cmp_lt_u32 s77, 1536
  s_cbranch_scc1 L_v5
  s_cmp_lt_u32 s77, 1792
  s_cbranch_scc1 L_v6
L_v7:
  v_and_b32_dpp v48, v57, v80 row_newbcast:0 row_mask:0xf bank_mask:0xf
  v_and_b32_dpp v49, v57, v81 row_newbcast:0 row_mask:0xf bank_mask:0xf
  v_and_b32_dpp v50, v57, v82 row_newbcast:0 row_mask:0xf bank_mask:0xf
  v_and_b32_dpp v51, v57, v83 row_newbcast:0 row_mask:0xf bank_mask:0xf
  v_and_b32_dpp v52, v57, v80 row_newbcast:4 row_mask:0xf bank_mask:0xf
  v_and_b32_dpp v53, v57, v81 row_newbcast:4 row_mask:0xf bank_mask:0xf
  v_and_b32_dpp v54, v57, v82 row_newbcast:4 row_mask:0xf bank_mask:0xf
  v_and_b32_dpp v55, v57, v83 row_newbcast:4 row_mask:0xf bank_mask:0xf
  s_waitcnt vmcnt(11)
  v_mfma_f32_16x16x32_bf16 v[44:47], a[0:3], v[48:51], v[44:47]
  buffer_load_dwordx4 a[0:3], v4, s[36:39], s74 offen offset:0 nt
  v_and_b32_dpp v48, v57, v80 row_newbcast:8 row_mask:0xf bank_mask:0xf
  v_and_b32_dpp v49, v57, v81 row_newbcast:8 row_mask:0xf bank_mask:0xf
  v_and_b32_dpp v50, v57, v82 row_newbcast:8 row_mask:0xf bank_mask:0xf
  v_and_b32_dpp v51, v57, v83 row_newbcast:8 row_mask:0xf bank_mask:0xf
  s_waitcnt vmcnt(12)
  v_mfma_f32_16x16x32_bf16 v[44:47], a[4:7], v[52:55], v[44:47]
  buffer_load_dwordx4 a[4:7], v4, s[36:39], s74 offen offset:1024 nt
  v_and_b32_dpp v52, v57, v80 row_newbcast:12 row_mask:0xf bank_mask:0xf
  v_and_b32_dpp v53, v57, v81 row_newbcast:12 row_mask:0xf bank_mask:0xf
  v_and_b32_dpp v54, v57, v82 row_newbcast:12 row_mask:0xf bank_mask:0xf
  v_and_b32_dpp v55, v57, v83 row_newbcast:12 row_mask:0xf bank_mask:0xf
  s_waitcnt vmcnt(11)
  v_mfma_f32_16x16x32_bf16 v[44:47], a[8:11], v[48:51], v[44:47]
  s_add_u32 s75, s74, 8192
  buffer_load_dwordx4 a[8:11], v4, s[36:39], s75 offen offset:0 nt
  v_and_b32_dpp v48, v57, v80 row_newbcast:1 row_mask:0xf bank_mask:0xf
  v_and_b32_dpp v49, v57, v81 row_newbcast:1 row_mask:0xf bank_mask:0xf
  v_and_b32_dpp v50, v57, v82 row_newbcast:1 row_mask:0xf bank_mask:0xf
  v_and_b32_dpp v51, v57, v83 row_newbcast:1 row_mask:0xf bank_mask:0xf
  s_waitcnt vmcnt(12)
  v_mfma_f32_16x16x32_bf16 v[44:47], a[12:15], v[52:55], v[44:47]
  buffer_load_dwordx4 a[12:15], v4, s[36:39], s75 offen offset:1024 nt
  v_and_b32_dpp v52, v57, v80 row_newbcast:5 row_mask:0xf bank_mask:0xf
  v_and_b32_dpp v53, v57, v81 row_newbcast:5 row_mask:0xf bank_mask:0xf
  v_and_b32_dpp v54, v57, v82 row_newbcast:5 row_mask:0xf bank_mask:0xf
  v_and_b32_dpp v55, v57, v83 row_newbcast:5 row_mask:0xf bank_mask:0xf
  s_waitcnt vmcnt(11)
  v_mfma_f32_16x16x32_bf16 v[44:47], a[16:19], v[48:51], v[44:47]
  buffer_load_dwordx4 a[16:19], v4, s[36:39], s74 offen offset:2048 nt
  v_and_b32_dpp v48, v57, v80 row_newbcast:9 row_mask:0xf bank_mask:0xf
  v_and_b32_dpp v49, v57, v81 row_newbcast:9 row_mask:0xf bank_mask:0xf
  v_and_b32_dpp v50, v57, v82 row_newbcast:9 row_mask:0xf bank_mask:0xf
  v_and_b32_dpp v51, v57, v83 row_newbcast:9 row_mask:0xf bank_mask:0xf
  s_waitcnt vmcnt(12)
  v_mfma_f32_16x16x32_bf16 v[44:47], a[20:23], v[52:55], v[44:47]
  buffer_load_dwordx4 a[20:23], v4, s[36:39], s74 offen offset:3072 nt
  v_and_b32_dpp v52, v57, v80 row_newbcast:13 row_mask:0xf bank_mask:0xf
  v_and_b32_dpp v53, v57, v81 row_newbcast:13 row_mask:0xf bank_mask:0xf
  v_and_b32_dpp v54, v57, v82 row_newbcast:13 row_mask:0xf bank_mask:0xf
  v_and_b32_dpp v55, v57, v83 row_newbcast:13 row_mask:0xf bank_mask:0xf
  s_waitcnt vmcnt(11)
  v_mfma_f32_16x16x32_bf16 v[44:47], a[24:27], v[48:51], v[44:47]
  s_add_u32 s75, s74, 8192
  buffer_load_dwordx4 a[24:27], v4, s[36:39], s75 offen offset:2048 nt
  v_and_b32_dpp v48, v57, v80 row_newbcast:2 row_mask:0xf bank_mask:0xf
  v_and_b32_dpp v49, v57, v81 row_newbcast:2 row_mask:0xf bank_mask:0xf
  v_and_b32_dpp v50, v57, v82 row_newbcast:2 row_mask:0xf bank_mask:0xf
  v_and_b32_dpp v51, v57, v83 row_newbcast:2 row_mask:0xf bank_mask:0xf
  s_waitcnt vmcnt(12)
  v_mfma_f32_16x16x32_bf16 v[44:47], a[28:31], v[52:55], v[44:47]
  buffer_load_dwordx4 a[28:31], v4, s[36:39], s75 offen offset:3072 nt
  v_and_b32_dpp v52, v57, v80 row_newbcast:6 row_mask:0xf bank_mask:0xf
  v_and_b32_dpp v53, v57, v81 row_newbcast:6 row_mask:0xf bank_mask:0xf
  v_and_b32_dpp v54, v57, v82 row_newbcast:6 row_mask:0xf bank_mask:0xf
  v_and_b32_dpp v55, v57, v83 row_newbcast:6 row_mask:0xf bank_mask:0xf
  s_waitcnt vmcnt(11)
  v_mfma_f32_16x16x32_bf16 v[44:47], a[32:35], v[48:51], v[44:47]
  s_add_u32 s75, s74, 16384
  buffer_load_dwordx4 a[32:35], v4, s[36:39], s75 offen offset:0 nt
  v_and_b32_dpp v48, v57, v80 row_newbcast:10 row_mask:0xf bank_mask:0xf
  v_and_b32_dpp v49, v57, v81 row_newbcast:10 row_mask:0xf bank_mask:0xf
  v_and_b32_dpp v50, v57, v82 row_newbcast:10 row_mask:0xf bank_mask:0xf
  v_and_b32_dpp v51, v57, v83 row_newbcast:10 row_mask:0xf bank_mask:0xf
  s_waitcnt vmcnt(12)
  v_mfma_f32_16x16x32_bf16 v[44:47], a[36:39], v[52:55], v[44:47]
  buffer_load_dwordx4 a[36:39], v4, s[36:39], s75 offen offset:1024 nt
  v_and_b32_dpp v52, v57, v80 row_newbcast:14 row_mask:0xf bank_mask:0xf
  v_and_b32_dpp v53, v57, v81 row_newbcast:14 row_mask:0xf bank_mask:0xf
  v_and_b32_dpp v54, v57, v82 row_newbcast:14 row_mask:0xf bank_mask:0xf
  v_and_b32_dpp v55, v57, v83 row_newbcast:14 row_mask:0xf bank_mask:0xf
  s_waitcnt vmcnt(11)
  v_mfma_f32_16x16x32_bf16 v[44:47], a[40:43], v[48:51], v[44:47]
  s_add_u32 s75, s74, 24576
  buffer_load_dwordx4 a[40:43], v4, s[36:39], s75 offen offset:0 nt
  v_and_b32_dpp v48, v57, v80 row_newbcast:3 row_mask:0xf bank_mask:0xf
  v_and_b32_dpp v49, v57, v81 row_newbcast:3 row_mask:0xf bank_mask:0xf
  v_and_b32_dpp v50, v57, v82 row_newbcast:3 row_mask:0xf bank_mask:0xf
  v_and_b32_dpp v51, v57, v83 row_newbcast:3 row_mask:0xf bank_mask:0xf
  s_waitcnt vmcnt(12)
  v_mfma_f32_16x16x32_bf16 v[44:47], a[44:47], v[52:55], v[44:47]
  buffer_load_dwordx4 a[44:47], v4, s[36:39], s75 offen offset:1024 nt
  v_and_b32_dpp v52, v57, v80 row_newbcast:7 row_mask:0xf bank_mask:0xf
  v_and_b32_dpp v53, v57, v81 row_newbcast:7 row_mask:0xf bank_mask:0xf
  v_and_b32_dpp v54, v57, v82 row_newbcast:7 row_mask:0xf bank_mask:0xf
  v_and_b32_dpp v55, v57, v83 row_newbcast:7 row_mask:0xf bank_mask:0xf
  s_waitcnt vmcnt(11)
  v_mfma_f32_16x16x32_bf16 v[44:47], a[48:51], v[48:51], v[44:47]
  s_add_u32 s75, s74, 16384
  buffer_load_dwordx4 a[48:51], v4, s[36:39], s75 offen offset:2048 nt
  v_and_b32_dpp v48, v57, v80 row_newbcast:11 row_mask:0xf bank_mask:0xf
  v_and_b32_dpp v49, v57, v81 row_newbcast:11 row_mask:0xf bank_mask:0xf
  v_and_b32_dpp v50, v57, v82 row_newbcast:11 row_mask:0xf bank_mask:0xf
  v_and_b32_dpp v51, v57, v83 row_newbcast:11 row_mask:0xf bank_mask:0xf
  s_waitcnt vmcnt(12)
  v_mfma_f32_16x16x32_bf16 v[44:47], a[52:55], v[52:55], v[44:47]
  buffer_load_dwordx4 a[52:55], v4, s[36:39], s75 offen offset:3072 nt
  v_and_b32_dpp v52, v57, v80 row_newbcast:15 row_mask:0xf bank_mask:0xf
  v_and_b32_dpp v53, v57, v81 row_newbcast:15 row_mask:0xf bank_mask:0xf
  v_and_b32_dpp v54, v57, v82 row_newbcast:15 row_mask:0xf bank_mask:0xf
  v_and_b32_dpp v55, v57, v83 row_newbcast:15 row_mask:0xf bank_mask:0xf
  s_waitcnt vmcnt(11)
  v_mfma_f32_16x16x32_bf16 v[44:47], a[56:59], v[48:51], v[44:47]
  s_add_u32 s75, s74, 24576
  buffer_load_dwordx4 a[56:59], v4, s[36:39], s75 offen offset:2048 nt
  s_waitcnt vmcnt(12)
  v_mfma_f32_16x16x32_bf16 v[44:47], a[60:63], v[52:55], v[44:47]
  buffer_load_dwordx4 a[60:63], v4, s[36:39], s75 offen offset:3072 nt
  s_mov_b32 s74, s73
  s_bfe_u32 s58, s76, 393216
  s_lshl_b32 s58, s58, 18
  s_add_u32 s74, s74, s58
  s_add_u32 s76, s76, 1
  ds_read_b32 v79, v74 offset:288
  s_branch L_step
L_v6:
  v_and_b32_dpp v48, v57, v80 row_newbcast:0 row_mask:0xf bank_mask:0xf
  v_and_b32_dpp v49, v57, v81 row_newbcast:0 row_mask:0xf bank_mask:0xf
  v_and_b32_dpp v50, v57, v82 row_newbcast:0 row_mask:0xf bank_mask:0xf
  v_and_b32_dpp v51, v57, v83 row_newbcast:0 row_mask:0xf bank_mask:0xf
  v_and_b32_dpp v52, v57, v80 row_newbcast:4 row_mask:0xf bank_mask:0xf
  v_and_b32_dpp v53, v57, v81 row_newbcast:4 row_mask:0xf bank_mask:0xf
  v_and_b32_dpp v54, v57, v82 row_newbcast:4 row_mask:0xf bank_mask:0xf
  v_and_b32_dpp v55, v57, v83 row_newbcast:4 row_mask:0xf bank_mask:0xf
  s_waitcnt vmcnt(11)
  v_mfma_f32_16x16x32_bf16 v[44:47], a[0:3], v[48:51], v[44:47]
  buffer_load_dwordx4 a[0:3], v4, s[36:39], s74 offen offset:0 nt
  v_and_b32_dpp v48, v57, v80 row_newbcast:8 row_mask:0xf bank_mask:0xf
  v_and_b32_dpp v49, v57, v81 row_newbcast:8 row_mask:0xf bank_mask:0xf
  v_and_b32_dpp v50, v57, v82 row_newbcast:8 row_mask:0xf bank_mask:0xf
  v_and_b32_dpp v51, v57, v83 row_newbcast:8 row_mask:0xf bank_mask:0xf
  s_waitcnt vmcnt(11)
  v_mfma_f32_16x16x32_bf16 v[44:47], a[4:7], v[52:55], v[44:47]
  buffer_load_dwordx4 a[4:7], v4, s[36:39], s74 offen offset:1024 nt
  v_and_b32_dpp v52, v57, v80 row_newbcast:12 row_mask:0xf bank_mask:0xf
  v_and_b32_dpp v53, v57, v81 row_newbcast:12 row_mask:0xf bank_mask:0xf
  v_and_b32_dpp v54, v57, v82 row_newbcast:12 row_mask:0xf bank_mask:0xf
  v_and_b32_dpp v55, v57, v83 row_newbcast:12 row_mask:0xf bank_mask:0xf
  s_waitcnt vmcnt(11)
  v_mfma_f32_16x16x32_bf16 v[44:47], a[8:11], v[48:51], v[44:47]
  s_add_u32 s75, s74, 8192
  buffer_load_dwordx4 a[8:11], v4, s[36:39], s75 offen offset:0 nt
  v_and_b32_dpp v48, v57, v80 row_newbcast:1 row_mask:0xf bank_mask:0xf
  v_and_b32_dpp v49, v57, v81 row_newbcast:1 row_mask:0xf bank_mask:0xf
  v_and_b32_dpp v50, v57, v82 row_newbcast:1 row_mask:0xf bank_mask:0xf
  v_and_b32_dpp v51, v57, v83 row_newbcast:1 row_mask:0xf bank_mask:0xf
  s_waitcnt vmcnt(11)
  v_mfma_f32_16x16x32_bf16 v[44:47], a[12:15], v[52:55], v[44:47]
  buffer_load_dwordx4 a[12:15], v4, s[36:39], s75 offen offset:1024 nt
  v_and_b32_dpp v52, v57, v80 row_newbcast:5 row_mask:0xf bank_mask:0xf
  v_and_b32_dpp v53, v57, v81 row_newbcast:5 row_mask:0xf bank_mask:0xf
  v_and_b32_dpp v54, v57, v82 row_newbcast:5 row_mask:0xf bank_mask:0xf
  v_and_b32_dpp v55, v57, v83 row_newbcast:5 row_mask:0xf bank_mask:0xf
  s_waitcnt vmcnt(11)
  v_mfma_f32_16x16x32_bf16 v[44:47], a[16:19], v[48:51], v[44:47]
  buffer_load_dwordx4 a[16:19], v4, s[36:39], s74 offen offset:2048 nt
  v_and_b32_dpp v48, v57, v80 row_newbcast:9 row_mask:0xf bank_mask:0xf
  v_and_b32_dpp v49, v57, v81 row_newbcast:9 row_mask:0xf bank_mask:0xf
  v_and_b32_dpp v50, v57, v82 row_newbcast:9 row_mask:0xf bank_mask:0xf
  v_and_b32_dpp v51, v57, v83 row_newbcast:9 row_mask:0xf bank_mask:0xf
  s_waitcnt vmcnt(11)
  v_mfma_f32_16x16x32_bf16 v[44:47], a[20:23], v[52:55], v[44:47]
  buffer_load_dwordx4 a[20:23], v4, s[36:39], s74 offen offset:3072 nt
  v_and_b32_dpp v52, v57, v80 row_newbcast:13 row_mask:0xf bank_mask:0xf
  v_and_b32_dpp v53, v57, v81 row_newbcast:13 row_mask:0xf bank_mask:0xf
  v_and_b32_dpp v54, v57, v82 row_newbcast:13 row_mask:0xf bank_mask:0xf
  v_and_b32_dpp v55, v57, v83 row_newbcast:13 row_mask:0xf bank_mask:0xf
  s_waitcnt vmcnt(11)
  v_mfma_f32_16x16x32_bf16 v[44:47], a[24:27], v[48:51], v[44:47]
  s_add_u32 s75, s74, 8192
  buffer_load_dwordx4 a[24:27], v4, s[36:39], s75 offen offset:2048 nt
  v_and_b32_dpp v48, v57, v80 row_newbcast:2 row_mask:0xf bank_mask:0xf
  v_and_b32_dpp v49, v57, v81 row_newbcast:2 row_mask:0xf bank_mask:0xf
  v_and_b32_dpp v50, v57, v82 row_newbcast:2 row_mask:0xf bank_mask:0xf
  v_and_b32_dpp v51, v57, v83 row_newbcast:2 row_mask:0xf bank_mask:0xf
  s_waitcnt vmcnt(11)
  v_mfma_f32_16x16x32_bf16 v[44:47], a[28:31], v[52:55], v[44:47]
  buffer_load_dwordx4 a[28:31], v4, s[36:39], s75 offen offset:3072 nt
  v_and_b32_dpp v52, v57, v80 row_newbcast:6 row_mask:0xf bank_mask:0xf
  v_and_b32_dpp v53, v57, v81 row_newbcast:6 row_mask:0xf bank_mask:0xf
  v_and_b32_dpp v54, v57, v82 row_newbcast:6 row_mask:0xf bank_mask:0xf
  v_and_b32_dpp v55, v57, v83 row_newbcast:6 row_mask:0xf bank_mask:0xf
  s_waitcnt vmcnt(11)
  v_mfma_f32_16x16x32_bf16 v[44:47], a[32:35], v[48:51], v[44:47]
  s_add_u32 s75, s74, 16384
  buffer_load_dwordx4 a[32:35], v4, s[36:39], s75 offen offset:0 nt
  v_and_b32_dpp v48, v57, v80 row_newbcast:10 row_mask:0xf bank_mask:0xf
  v_and_b32_dpp v49, v57, v81 row_newbcast:10 row_mask:0xf bank_mask:0xf
  v_and_b32_dpp v50, v57, v82 row_newbcast:10 row_mask:0xf bank_mask:0xf
  v_and_b32_dpp v51, v57, v83 row_newbcast:10 row_mask:0xf bank_mask:0xf
  s_waitcnt vmcnt(11)
  v_mfma_f32_16x16x32_bf16 v[44:47], a[36:39], v[52:55], v[44:47]
  buffer_load_dwordx4 a[36:39], v4, s[36:39], s75 offen offset:1024 nt
  v_and_b32_dpp v52, v57, v80 row_newbcast:14 row_mask:0xf bank_mask:0xf
  v_and_b32_dpp v53, v57, v81 row_newbcast:14 row_mask:0xf bank_mask:0xf
  v_and_b32_dpp v54, v57, v82 row_newbcast:14 row_mask:0xf bank_mask:0xf
  v_and_b32_dpp v55, v57, v83 row_newbcast:14 row_mask:0xf bank_mask:0xf
  s_waitcnt vmcnt(11)
  v_mfma_f32_16x16x32_bf16 v[44:47], a[40:43], v[48:51], v[44:47]
  s_add_u32 s75, s74, 24576
  buffer_load_dwordx4 a[40:43], v4, s[36:39], s75 offen offset:0 nt
  v_and_b32_dpp v48, v57, v80 row_newbcast:3 row_mask:0xf bank_mask:0xf
  v_and_b32_dpp v49, v57, v81 row_newbcast:3 row_mask:0xf bank_mask:0xf
  v_and_b32_dpp v50, v57, v82 row_newbcast:3 row_mask:0xf bank_mask:0xf
  v_and_b32_dpp v51, v57, v83 row_newbcast:3 row_mask:0xf bank_mask:0xf
  s_waitcnt vmcnt(11)
  v_mfma_f32_16x16x32_bf16 v[44:47], a[44:47], v[52:55], v[44:47]
  buffer_load_dwordx4 a[44:47], v4, s[36:39], s75 offen offset:1024 nt
  v_and_b32_dpp v52, v57, v80 row_newbcast:7 row_mask:0xf bank_mask:0xf
  v_and_b32_dpp v53, v57, v81 row_newbcast:7 row_mask:0xf bank_mask:0xf
  v_and_b32_dpp v54, v57, v82 row_newbcast:7 row_mask:0xf bank_mask:0xf
  v_and_b32_dpp v55, v57, v83 row_newbcast:7 row_mask:0xf bank_mask:0xf
  s_waitcnt vmcnt(11)
  v_mfma_f32_16x16x32_bf16 v[44:47], a[48:51], v[48:51], v[44:47]
  s_add_u32 s75, s74, 16384
  buffer_load_dwordx4 a[48:51], v4, s[36:39], s75 offen offset:2048 nt
  v_and_b32_dpp v48, v57, v80 row_newbcast:11 row_mask:0xf bank_mask:0xf
  v_and_b32_dpp v49, v57, v81 row_newbcast:11 row_mask:0xf bank_mask:0xf
  v_and_b32_dpp v50, v57, v82 row_newbcast:11 row_mask:0xf bank_mask:0xf
  v_and_b32_dpp v51, v57, v83 row_newbcast:11 row_mask:0xf bank_mask:0xf
  s_waitcnt vmcnt(11)
  v_mfma_f32_16x16x32_bf16 v[44:47], a[52:55], v[52:55], v[44:47]
  buffer_load_dwordx4 a[52:55], v4, s[36:39], s75 offen offset:3072 nt
  v_and_b32_dpp v52, v57, v80 row_newbcast:15 row_mask:0xf bank_mask:0xf
  v_and_b32_dpp v53, v57, v81 row_newbcast:15 row_mask:0xf bank_mask:0xf
  v_and_b32_dpp v54, v57, v82 row_newbcast:15 row_mask:0xf bank_mask:0xf
  v_and_b32_dpp v55, v57, v83 row_newbcast:15 row_mask:0xf bank_mask:0xf
  s_waitcnt vmcnt(11)
  v_mfma_f32_16x16x32_bf16 v[44:47], a[56:59], v[48:51], v[44:47]
  s_add_u32 s75, s74, 24576
  buffer_load_dwordx4 a[56:59], v4, s[36:39], s75 offen offset:2048 nt
  s_waitcnt vmcnt(11)
  v_mfma_f32_16x16x32_bf16 v[44:47], a[60:63], v[52:55], v[44:47]
  buffer_load_dwordx4 a[60:63], v4, s[36:39], s75 offen offset:3072 nt
  s_mov_b32 s74, s73
  s_bfe_u32 s58, s76, 393216
  s_lshl_b32 s58, s58, 18
  s_add_u32 s74, s74, s58
  s_add_u32 s76, s76, 1
  ds_read_b32 v79, v74 offset:288
  s_branch L_step
L_v5:
  v_and_b32_dpp v48, v57, v80 row_newbcast:0 row_mask:0xf bank_mask:0xf
  v_and_b32_dpp v49, v57, v81 row_newbcast:0 row_mask:0xf bank_mask:0xf
  v_and_b32_dpp v50, v57, v82 row_newbcast:0 row_mask:0xf bank_mask:0xf
  v_and_b32_dpp v51, v57, v83 row_newbcast:0 row_mask:0xf bank_mask:0xf
  v_and_b32_dpp v52, v57, v80 row_newbcast:4 row_mask:0xf bank_mask:0xf
  v_and_b32_dpp v53, v57, v81 row_newbcast:4 row_mask:0xf bank_mask:0xf
  v_and_b32_dpp v54, v57, v82 row_newbcast:4 row_mask:0xf bank_mask:0xf
  v_and_b32_dpp v55, v57, v83 row_newbcast:4 row_mask:0xf bank_mask:0xf
  s_waitcnt vmcnt(10)
  v_mfma_f32_16x16x32_bf16 v[44:47], a[0:3], v[48:51], v[44:47]
  buffer_load_dwordx4 a[0:3], v4, s[36:39], s74 offen offset:0 nt
  v_and_b32_dpp v48, v57, v80 row_newbcast:8 row_mask:0xf bank_mask:0xf
  v_and_b32_dpp v49, v57, v81 row_newbcast:8 row_mask:0xf bank_mask:0xf
  v_and_b32_dpp v50, v57, v82 row_newbcast:8 row_mask:0xf bank_mask:0xf
  v_and_b32_dpp v51, v57, v83 row_newbcast:8 row_mask:0xf bank_mask:0xf
  s_waitcnt vmcnt(11)
  v_mfma_f32_16x16x32_bf16 v[44:47], a[4:7], v[52:55], v[44:47]
  buffer_load_dwordx4 a[4:7], v4, s[36:39], s74 offen offset:1024 nt
  v_and_b32_dpp v52, v57, v80 row_newbcast:12 row_mask:0xf bank_mask:0xf
  v_and_b32_dpp v53, v57, v81 row_newbcast:12 row_mask:0xf bank_mask:0xf
  v_and_b32_dpp v54, v57, v82 row_newbcast:12 row_mask:0xf bank_mask:0xf
  v_and_b32_dpp v55, v57, v83 row_newbcast:12 row_mask:0xf bank_mask:0xf
  s_waitcnt vmcnt(10)
  v_mfma_f32_16x16x32_bf16 v[44:47], a[8:11], v[48:51], v[44:47]
  s_add_u32 s75, s74, 8192
  buffer_load_dwordx4 a[8:11], v4, s[36:39], s75 offen offset:0 nt
  v_and_b32_dpp v48, v57, v80 row_newbcast:1 row_mask:0xf bank_mask:0xf
  v_and_b32_dpp v49, v57, v81 row_newbcast:1 row_mask:0xf bank_mask:0xf
  v_and_b32_dpp v50, v57, v82 row_newbcast:1 row_mask:0xf bank_mask:0xf
  v_and_b32_dpp v51, v57, v83 row_newbcast:1 row_mask:0xf bank_mask:0xf
  s_waitcnt vmcnt(11)
  v_mfma_f32_16x16x32_bf16 v[44:47], a[12:15], v[52:55], v[44:47]
  buffer_load_dwordx4 a[12:15], v4, s[36:39], s75 offen offset:1024 nt
  v_and_b32_dpp v52, v57, v80 row_newbcast:5 row_mask:0xf bank_mask:0xf
  v_and_b32_dpp v53, v57, v81 row_newbcast:5 row_mask:0xf bank_mask:0xf
  v_and_b32_dpp v54, v57, v82 row_newbcast:5 row_mask:0xf bank_mask:0xf
  v_and_b32_dpp v55, v57, v83 row_newbcast:5 row_mask:0xf bank_mask:0xf
  s_waitcnt vmcnt(10)
  v_mfma_f32_16x16x32_bf16 v[44:47], a[16:19], v[48:51], v[44:47]
  buffer_load_dwordx4 a[16:19], v4, s[36:39], s74 offen offset:2048 nt
  v_and_b32_dpp v48, v57, v80 row_newbcast:9 row_mask:0xf bank_mask:0xf
  v_and_b32_dpp v49, v57, v81 row_newbcast:9 row_mask:0xf bank_mask:0xf
  v_and_b32_dpp v50, v57, v82 row_newbcast:9 row_mask:0xf bank_mask:0xf
  v_and_b32_dpp v51, v57, v83 row_newbcast:9 row_mask:0xf bank_mask:0xf
  s_waitcnt vmcnt(11)
  v_mfma_f32_16x16x32_bf16 v[44:47], a[20:23], v[52:55], v[44:47]
  buffer_load_dwordx4 a[20:23], v4, s[36:39], s74 offen offset:3072 nt
  v_and_b32_dpp v52, v57, v80 row_newbcast:13 row_mask:0xf bank_mask:0xf
  v_and_b32_dpp v53, v57, v81 row_newbcast:13 row_mask:0xf bank_mask:0xf
  v_and_b32_dpp v54, v57, v82 row_newbcast:13 row_mask:0xf bank_mask:0xf
  v_and_b32_dpp v55, v57, v83 row_newbcast:13 row_mask:0xf bank_mask:0xf
  s_waitcnt vmcnt(10)
  v_mfma_f32_16x16x32_bf16 v[44:47], a[24:27], v[48:51], v[44:47]
  s_add_u32 s75, s74, 8192
  buffer_load_dwordx4 a[24:27], v4, s[36:39], s75 offen offset:2048 nt
  v_and_b32_dpp v48, v57, v80 row_newbcast:2 row_mask:0xf bank_mask:0xf
  v_and_b32_dpp v49, v57, v81 row_newbcast:2 row_mask:0xf bank_mask:0xf
  v_and_b32_dpp v50, v57, v82 row_newbcast:2 row_mask:0xf bank_mask:0xf
  v_and_b32_dpp v51, v57, v83 row_newbcast:2 row_mask:0xf bank_mask:0xf
  s_waitcnt vmcnt(11)
  v_mfma_f32_16x16x32_bf16 v[44:47], a[28:31], v[52:55], v[44:47]
  buffer_load_dwordx4 a[28:31], v4, s[36:39], s75 offen offset:3072 nt
  v_and_b32_dpp v52, v57, v80 row_newbcast:6 row_mask:0xf bank_mask:0xf
  v_and_b32_dpp v53, v57, v81 row_newbcast:6 row_mask:0xf bank_mask:0xf
  v_and_b32_dpp v54, v57, v82 row_newbcast:6 row_mask:0xf bank_mask:0xf
  v_and_b32_dpp v55, v57, v83 row_newbcast:6 row_mask:0xf bank_mask:0xf
  s_waitcnt vmcnt(10)
  v_mfma_f32_16x16x32_bf16 v[44:47], a[32:35], v[48:51], v[44:47]
  s_add_u32 s75, s74, 16384
  buffer_load_dwordx4 a[32:35], v4, s[36:39], s75 offen offset:0 nt
  v_and_b32_dpp v48, v57, v80 row_newbcast:10 row_mask:0xf bank_mask:0xf
  v_and_b32_dpp v49, v57, v81 row_newbcast:10 row_mask:0xf bank_mask:0xf
  v_and_b32_dpp v50, v57, v82 row_newbcast:10 row_mask:0xf bank_mask:0xf
  v_and_b32_dpp v51, v57, v83 row_newbcast:10 row_mask:0xf bank_mask:0xf
  s_waitcnt vmcnt(11)
  v_mfma_f32_16x16x32_bf16 v[44:47], a[36:39], v[52:55], v[44:47]
  buffer_load_dwordx4 a[36:39], v4, s[36:39], s75 offen offset:1024 nt
  v_and_b32_dpp v52, v57, v80 row_newbcast:14 row_mask:0xf bank_mask:0xf
  v_and_b32_dpp v53, v57, v81 row_newbcast:14 row_mask:0xf bank_mask:0xf
  v_and_b32_dpp v54, v57, v82 row_newbcast:14 row_mask:0xf bank_mask:0xf
  v_and_b32_dpp v55, v57, v83 row_newbcast:14 row_mask:0xf bank_mask:0xf
  s_waitcnt vmcnt(10)
  v_mfma_f32_16x16x32_bf16 v[44:47], a[40:43], v[48:51], v[44:47]
  s_add_u32 s75, s74, 24576
  buffer_load_dwordx4 a[40:43], v4, s[36:39], s75 offen offset:0 nt
  v_and_b32_dpp v48, v57, v80 row_newbcast:3 row_mask:0xf bank_mask:0xf
  v_and_b32_dpp v49, v57, v81 row_newbcast:3 row_mask:0xf bank_mask:0xf
  v_and_b32_dpp v50, v57, v82 row_newbcast:3 row_mask:0xf bank_mask:0xf
  v_and_b32_dpp v51, v57, v83 row_newbcast:3 row_mask:0xf bank_mask:0xf
  s_waitcnt vmcnt(11)
  v_mfma_f32_16x16x32_bf16 v[44:47], a[44:47], v[52:55], v[44:47]
  buffer_load_dwordx4 a[44:47], v4, s[36:39], s75 offen offset:1024 nt
  v_and_b32_dpp v52, v57, v80 row_newbcast:7 row_mask:0xf bank_mask:0xf
  v_and_b32_dpp v53, v57, v81 row_newbcast:7 row_mask:0xf bank_mask:0xf
  v_and_b32_dpp v54, v57, v82 row_newbcast:7 row_mask:0xf bank_mask:0xf
  v_and_b32_dpp v55, v57, v83 row_newbcast:7 row_mask:0xf bank_mask:0xf
  s_waitcnt vmcnt(10)
  v_mfma_f32_16x16x32_bf16 v[44:47], a[48:51], v[48:51], v[44:47]
  s_add_u32 s75, s74, 16384
  buffer_load_dwordx4 a[48:51], v4, s[36:39], s75 offen offset:2048 nt
  v_and_b32_dpp v48, v57, v80 row_newbcast:11 row_mask:0xf bank_mask:0xf
  v_and_b32_dpp v49, v57, v81 row_newbcast:11 row_mask:0xf bank_mask:0xf
  v_and_b32_dpp v50, v57, v82 row_newbcast:11 row_mask:0xf bank_mask:0xf
  v_and_b32_dpp v51, v57, v83 row_newbcast:11 row_mask:0xf bank_mask:0xf
  s_waitcnt vmcnt(11)
  v_mfma_f32_16x16x32_bf16 v[44:47], a[52:55], v[52:55], v[44:47]
  buffer_load_dwordx4 a[52:55], v4, s[36:39], s75 offen offset:3072 nt
  v_and_b32_dpp v52, v57, v80 row_newbcast:15 row_mask:0xf bank_mask:0xf
  v_and_b32_dpp v53, v57, v81 row_newbcast:15 row_mask:0xf bank_mask:0xf
  v_and_b32_dpp v54, v57, v82 row_newbcast:15 row_mask:0xf bank_mask:0xf
  v_and_b32_dpp v55, v57, v83 row_newbcast:15 row_mask:0xf bank_mask:0xf
  s_waitcnt vmcnt(10)
  v_mfma_f32_16x16x32_bf16 v[44:47], a[56:59], v[48:51], v[44:47]
  s_add_u32 s75, s74, 24576
  buffer_load_dwordx4 a[56:59], v4, s[36:39], s75 offen offset:2048 nt
  s_waitcnt vmcnt(11)
  v_mfma_f32_16x16x32_bf16 v[44:47], a[60:63], v[52:55], v[44:47]
  buffer_load_dwordx4 a[60:63], v4, s[36:39], s75 offen offset:3072 nt
  s_mov_b32 s74, s73
  s_bfe_u32 s58, s76, 393216
  s_lshl_b32 s58, s58, 18
  s_add_u32 s74, s74, s58
  s_add_u32 s76, s76, 1
  ds_read_b32 v79, v74 offset:288
  s_branch L_step
L_v4:
  v_and_b32_dpp v48, v57, v80 row_newbcast:0 row_mask:0xf bank_mask:0xf
  v_and_b32_dpp v49, v57, v81 row_newbcast:0 row_mask:0xf bank_mask:0xf
  v_and_b32_dpp v50, v57, v82 row_newbcast:0 row_mask:0xf bank_mask:0xf
  v_and_b32_dpp v51, v57, v83 row_newbcast:0 row_mask:0xf bank_mask:0xf
  v_and_b32_dpp v52, v57, v80 row_newbcast:4 row_mask:0xf bank_mask:0xf
  v_and_b32_dpp v53, v57, v81 row_newbcast:4 row_mask:0xf bank_mask:0xf
  v_and_b32_dpp v54, v57, v82 row_newbcast:4 row_mask:0xf bank_mask:0xf
  v_and_b32_dpp v55, v57, v83 row_newbcast:4 row_mask:0xf bank_mask:0xf
  s_waitcnt vmcnt(10)
  v_mfma_f32_16x16x32_bf16 v[44:47], a[0:3], v[48:51], v[44:47]
  buffer_load_dwordx4 a[0:3], v4, s[36:39], s74 offen offset:0 nt
  v_and_b32_dpp v48, v57, v80 row_newbcast:8 row_mask:0xf bank_mask:0xf
  v_and_b32_dpp v49, v57, v81 row_newbcast:8 row_mask:0xf bank_mask:0xf
  v_and_b32_dpp v50, v57, v82 row_newbcast:8 row_mask:0xf bank_mask:0xf
  v_and_b32_dpp v51, v57, v83 row_newbcast:8 row_mask:0xf bank_mask:0xf
  s_waitcnt vmcnt(10)
  v_mfma_f32_16x16x32_bf16 v[44:47], a[4:7], v[52:55], v[44:47]
  buffer_load_dwordx4 a[4:7], v4, s[36:39], s74 offen offset:1024 nt
  v_and_b32_dpp v52, v57, v80 row_newbcast:12 row_mask:0xf bank_mask:0xf
  v_and_b32_dpp v53, v57, v81 row_newbcast:12 row_mask:0xf bank_mask:0xf
  v_and_b32_dpp v54, v57, v82 row_newbcast:12 row_mask:0xf bank_mask:0xf
  v_and_b32_dpp v55, v57, v83 row_newbcast:12 row_mask:0xf bank_mask:0xf
  s_waitcnt vmcnt(10)
  v_mfma_f32_16x16x32_bf16 v[44:47], a[8:11], v[48:51], v[44:47]
  s_add_u32 s75, s74, 8192
  buffer_load_dwordx4 a[8:11], v4, s[36:39], s75 offen offset:0 nt
  v_and_b32_dpp v48, v57, v80 row_newbcast:1 row_mask:0xf bank_mask:0xf
  v_and_b32_dpp v49, v57, v81 row_newbcast:1 row_mask:0xf bank_mask:0xf
  v_and_b32_dpp v50, v57, v82 row_newbcast:1 row_mask:0xf bank_mask:0xf
  v_and_b32_dpp v51, v57, v83 row_newbcast:1 row_mask:0xf bank_mask:0xf
  s_waitcnt vmcnt(10)
  v_mfma_f32_16x16x32_bf16 v[44:47], a[12:15], v[52:55], v[44:47]
  buffer_load_dwordx4 a[12:15], v4, s[36:39], s75 offen offset:1024 nt
  v_and_b32_dpp v52, v57, v80 row_newbcast:5 row_mask:0xf bank_mask:0xf
  v_and_b32_dpp v53, v57, v81 row_newbcast:5 row_mask:0xf bank_mask:0xf
  v_and_b32_dpp v54, v57, v82 row_newbcast:5 row_mask:0xf bank_mask:0xf
  v_and_b32_dpp v55, v57, v83 row_newbcast:5 row_mask:0xf bank_mask:0xf
  s_waitcnt vmcnt(10)
  v_mfma_f32_16x16x32_bf16 v[44:47], a[16:19], v[48:51], v[44:47]
  buffer_load_dwordx4 a[16:19], v4, s[36:39], s74 offen offset:2048 nt
  v_and_b32_dpp v48, v57, v80 row_newbcast:9 row_mask:0xf bank_mask:0xf
  v_and_b32_dpp v49, v57, v81 row_newbcast:9 row_mask:0xf bank_mask:0xf
  v_and_b32_dpp v50, v57, v82 row_newbcast:9 row_mask:0xf bank_mask:0xf
  v_and_b32_dpp v51, v57, v83 row_newbcast:9 row_mask:0xf bank_mask:0xf
  s_waitcnt vmcnt(10)
  v_mfma_f32_16x16x32_bf16 v[44:47], a[20:23], v[52:55], v[44:47]
  buffer_load_dwordx4 a[20:23], v4, s[36:39], s74 offen offset:3072 nt
  v_and_b32_dpp v52, v57, v80 row_newbcast:13 row_mask:0xf bank_mask:0xf
  v_and_b32_dpp v53, v57, v81 row_newbcast:13 row_mask:0xf bank_mask:0xf
  v_and_b32_dpp v54, v57, v82 row_newbcast:13 row_mask:0xf bank_mask:0xf
  v_and_b32_dpp v55, v57, v83 row_newbcast:13 row_mask:0xf bank_mask:0xf
  s_waitcnt vmcnt(10)
  v_mfma_f32_16x16x32_bf16 v[44:47], a[24:27], v[48:51], v[44:47]
  s_add_u32 s75, s74, 8192
  buffer_load_dwordx4 a[24:27], v4, s[36:39], s75 offen offset:2048 nt
  v_and_b32_dpp v48, v57, v80 row_newbcast:2 row_mask:0xf bank_mask:0xf
  v_and_b32_dpp v49, v57, v81 row_newbcast:2 row_mask:0xf bank_mask:0xf
  v_and_b32_dpp v50, v57, v82 row_newbcast:2 row_mask:0xf bank_mask:0xf
  v_and_b32_dpp v51, v57, v83 row_newbcast:2 row_mask:0xf bank_mask:0xf
  s_waitcnt vmcnt(10)
  v_mfma_f32_16x16x32_bf16 v[44:47], a[28:31], v[52:55], v[44:47]
  buffer_load_dwordx4 a[28:31], v4, s[36:39], s75 offen offset:3072 nt
  v_and_b32_dpp v52, v57, v80 row_newbcast:6 row_mask:0xf bank_mask:0xf
  v_and_b32_dpp v53, v57, v81 row_newbcast:6 row_mask:0xf bank_mask:0xf
  v_and_b32_dpp v54, v57, v82 row_newbcast:6 row_mask:0xf bank_mask:0xf
  v_and_b32_dpp v55, v57, v83 row_newbcast:6 row_mask:0xf bank_mask:0xf
  s_waitcnt vmcnt(10)
  v_mfma_f32_16x16x32_bf16 v[44:47], a[32:35], v[48:51], v[44:47]
  s_add_u32 s75, s74, 16384
  buffer_load_dwordx4 a[32:35], v4, s[36:39], s75 offen offset:0 nt
  v_and_b32_dpp v48, v57, v80 row_newbcast:10 row_mask:0xf bank_mask:0xf
  v_and_b32_dpp v49, v57, v81 row_newbcast:10 row_mask:0xf bank_mask:0xf
  v_and_b32_dpp v50, v57, v82 row_newbcast:10 row_mask:0xf bank_mask:0xf
  v_and_b32_dpp v51, v57, v83 row_newbcast:10 row_mask:0xf bank_mask:0xf
  s_waitcnt vmcnt(10)
  v_mfma_f32_16x16x32_bf16 v[44:47], a[36:39], v[52:55], v[44:47]
  buffer_load_dwordx4 a[36:39], v4, s[36:39], s75 offen offset:1024 nt
  v_and_b32_dpp v52, v57, v80 row_newbcast:14 row_mask:0xf bank_mask:0xf
  v_and_b32_dpp v53, v57, v81 row_newbcast:14 row_mask:0xf bank_mask:0xf
  v_and_b32_dpp v54, v57, v82 row_newbcast:14 row_mask:0xf bank_mask:0xf
  v_and_b32_dpp v55, v57, v83 row_newbcast:14 row_mask:0xf bank_mask:0xf
  s_waitcnt vmcnt(10)
  v_mfma_f32_16x16x32_bf16 v[44:47], a[40:43], v[48:51], v[44:47]
  s_add_u32 s75, s74, 24576
  buffer_load_dwordx4 a[40:43], v4, s[36:39], s75 offen offset:0 nt
  v_and_b32_dpp v48, v57, v80 row_newbcast:3 row_mask:0xf bank_mask:0xf
  v_and_b32_dpp v49, v57, v81 row_newbcast:3 row_mask:0xf bank_mask:0xf
  v_and_b32_dpp v50, v57, v82 row_newbcast:3 row_mask:0xf bank_mask:0xf
  v_and_b32_dpp v51, v57, v83 row_newbcast:3 row_mask:0xf bank_mask:0xf
  s_waitcnt vmcnt(10)
  v_mfma_f32_16x16x32_bf16 v[44:47], a[44:47], v[52:55], v[44:47]
  buffer_load_dwordx4 a[44:47], v4, s[36:39], s75 offen offset:1024 nt
  v_and_b32_dpp v52, v57, v80 row_newbcast:7 row_mask:0xf bank_mask:0xf
  v_and_b32_dpp v53, v57, v81 row_newbcast:7 row_mask:0xf bank_mask:0xf
  v_and_b32_dpp v54, v57, v82 row_newbcast:7 row_mask:0xf bank_mask:0xf
  v_and_b32_dpp v55, v57, v83 row_newbcast:7 row_mask:0xf bank_mask:0xf
  s_waitcnt vmcnt(10)
  v_mfma_f32_16x16x32_bf16 v[44:47], a[48:51], v[48:51], v[44:47]
  s_add_u32 s75, s74, 16384
  buffer_load_dwordx4 a[48:51], v4, s[36:39], s75 offen offset:2048 nt
  v_and_b32_dpp v48, v57, v80 row_newbcast:11 row_mask:0xf bank_mask:0xf
  v_and_b32_dpp v49, v57, v81 row_newbcast:11 row_mask:0xf bank_mask:0xf
  v_and_b32_dpp v50, v57, v82 row_newbcast:11 row_mask:0xf bank_mask:0xf
  v_and_b32_dpp v51, v57, v83 row_newbcast:11 row_mask:0xf bank_mask:0xf
  s_waitcnt vmcnt(10)
  v_mfma_f32_16x16x32_bf16 v[44:47], a[52:55], v[52:55], v[44:47]
  buffer_load_dwordx4 a[52:55], v4, s[36:39], s75 offen offset:3072 nt
  v_and_b32_dpp v52, v57, v80 row_newbcast:15 row_mask:0xf bank_mask:0xf
  v_and_b32_dpp v53, v57, v81 row_newbcast:15 row_mask:0xf bank_mask:0xf
  v_and_b32_dpp v54, v57, v82 row_newbcast:15 row_mask:0xf bank_mask:0xf
  v_and_b32_dpp v55, v57, v83 row_newbcast:15 row_mask:0xf bank_mask:0xf
  s_waitcnt vmcnt(10)
  v_mfma_f32_16x16x32_bf16 v[44:47], a[56:59], v[48:51], v[44:47]
  s_add_u32 s75, s74, 24576
  buffer_load_dwordx4 a[56:59], v4, s[36:39], s75 offen offset:2048 nt
  s_waitcnt vmcnt(10)
  v_mfma_f32_16x16x32_bf16 v[44:47], a[60:63], v[52:55], v[44:47]
  buffer_load_dwordx4 a[60:63], v4, s[36:39], s75 offen offset:3072 nt
  s_mov_b32 s74, s73
  s_bfe_u32 s58, s76, 393216
  s_lshl_b32 s58, s58, 18
  s_add_u32 s74, s74, s58
  s_add_u32 s76, s76, 1
  ds_read_b32 v79, v74 offset:288
  s_branch L_step
L_v3:
  v_and_b32_dpp v48, v57, v80 row_newbcast:0 row_mask:0xf bank_mask:0xf
  v_and_b32_dpp v49, v57, v81 row_newbcast:0 row_mask:0xf bank_mask:0xf
  v_and_b32_dpp v50, v57, v82 row_newbcast:0 row_mask:0xf bank_mask:0xf
  v_and_b32_dpp v51, v57, v83 row_newbcast:0 row_mask:0xf bank_mask:0xf
  v_and_b32_dpp v52, v57, v80 row_newbcast:4 row_mask:0xf bank_mask:0xf
  v_and_b32_dpp v53, v57, v81 row_newbcast:4 row_mask:0xf bank_mask:0xf
  v_and_b32_dpp v54, v57, v82 row_newbcast:4 row_mask:0xf bank_mask:0xf
  v_and_b32_dpp v55, v57, v83 row_newbcast:4 row_mask:0xf bank_mask:0xf
  s_waitcnt vmcnt(9)
  v_mfma_f32_16x16x32_bf16 v[44:47], a[0:3], v[48:51], v[44:47]
  buffer_load_dwordx4 a[0:3], v4, s[36:39], s74 offen offset:0 nt
  v_and_b32_dpp v48, v57, v80 row_newbcast:8 row_mask:0xf bank_mask:0xf
  v_and_b32_dpp v49, v57, v81 row_newbcast:8 row_mask:0xf bank_mask:0xf
  v_and_b32_dpp v50, v57, v82 row_newbcast:8 row_mask:0xf bank_mask:0xf
  v_and_b32_dpp v51, v57, v83 row_newbcast:8 row_mask:0xf bank_mask:0xf
  s_waitcnt vmcnt(10)
  v_mfma_f32_16x16x32_bf16 v[44:47], a[4:7], v[52:55], v[44:47]
  buffer_load_dwordx4 a[4:7], v4, s[36:39], s74 offen offset:1024 nt
  v_and_b32_dpp v52, v57, v80 row_newbcast:12 row_mask:0xf bank_mask:0xf
  v_and_b32_dpp v53, v57, v81 row_newbcast:12 row_mask:0xf bank_mask:0xf
  v_and_b32_dpp v54, v57, v82 row_newbcast:12 row_mask:0xf bank_mask:0xf
  v_and_b32_dpp v55, v57, v83 row_newbcast:12 row_mask:0xf bank_mask:0xf
  s_waitcnt vmcnt(9)
  v_mfma_f32_16x16x32_bf16 v[44:47], a[8:11], v[48:51], v[44:47]
  s_add_u32 s75, s74, 8192
  buffer_load_dwordx4 a[8:11], v4, s[36:39], s75 offen offset:0 nt
  v_and_b32_dpp v48, v57, v80 row_newbcast:1 row_mask:0xf bank_mask:0xf
  v_and_b32_dpp v49, v57, v81 row_newbcast:1 row_mask:0xf bank_mask:0xf
  v_and_b32_dpp v50, v57, v82 row_newbcast:1 row_mask:0xf bank_mask:0xf
  v_and_b32_dpp v51, v57, v83 row_newbcast:1 row_mask:0xf bank_mask:0xf
  s_waitcnt vmcnt(10)
  v_mfma_f32_16x16x32_bf16 v[44:47], a[12:15], v[52:55], v[44:47]
  buffer_load_dwordx4 a[12:15], v4, s[36:39], s75 offen offset:1024 nt
  v_and_b32_dpp v52, v57, v80 row_newbcast:5 row_mask:0xf bank_mask:0xf
  v_and_b32_dpp v53, v57, v81 row_newbcast:5 row_mask:0xf bank_mask:0xf
  v_and_b32_dpp v54, v57, v82 row_newbcast:5 row_mask:0xf bank_mask:0xf
  v_and_b32_dpp v55, v57, v83 row_newbcast:5 row_mask:0xf bank_mask:0xf
  s_waitcnt vmcnt(9)
  v_mfma_f32_16x16x32_bf16 v[44:47], a[16:19], v[48:51], v[44:47]
  buffer_load_dwordx4 a[16:19], v4, s[36:39], s74 offen offset:2048 nt
  v_and_b32_dpp v48, v57, v80 row_newbcast:9 row_mask:0xf bank_mask:0xf
  v_and_b32_dpp v49, v57, v81 row_newbcast:9 row_mask:0xf bank_mask:0xf
  v_and_b32_dpp v50, v57, v82 row_newbcast:9 row_mask:0xf bank_mask:0xf
  v_and_b32_dpp v51, v57, v83 row_newbcast:9 row_mask:0xf bank_mask:0xf
  s_waitcnt vmcnt(10)
  v_mfma_f32_16x16x32_bf16 v[44:47], a[20:23], v[52:55], v[44:47]
  buffer_load_dwordx4 a[20:23], v4, s[36:39], s74 offen offset:3072 nt
  v_and_b32_dpp v52, v57, v80 row_newbcast:13 row_mask:0xf bank_mask:0xf
  v_and_b32_dpp v53, v57, v81 row_newbcast:13 row_mask:0xf bank_mask:0xf
  v_and_b32_dpp v54, v57, v82 row_newbcast:13 row_mask:0xf bank_mask:0xf
  v_and_b32_dpp v55, v57, v83 row_newbcast:13 row_mask:0xf bank_mask:0xf
  s_waitcnt vmcnt(9)
  v_mfma_f32_16x16x32_bf16 v[44:47], a[24:27], v[48:51], v[44:47]
  s_add_u32 s75, s74, 8192
  buffer_load_dwordx4 a[24:27], v4, s[36:39], s75 offen offset:2048 nt
  v_and_b32_dpp v48, v57, v80 row_newbcast:2 row_mask:0xf bank_mask:0xf
  v_and_b32_dpp v49, v57, v81 row_newbcast:2 row_mask:0xf bank_mask:0xf
  v_and_b32_dpp v50, v57, v82 row_newbcast:2 row_mask:0xf bank_mask:0xf
  v_and_b32_dpp v51, v57, v83 row_newbcast:2 row_mask:0xf bank_mask:0xf
  s_waitcnt vmcnt(10)
  v_mfma_f32_16x16x32_bf16 v[44:47], a[28:31], v[52:55], v[44:47]
  buffer_load_dwordx4 a[28:31], v4, s[36:39], s75 offen offset:3072 nt
  v_and_b32_dpp v52, v57, v80 row_newbcast:6 row_mask:0xf bank_mask:0xf
  v_and_b32_dpp v53, v57, v81 row_newbcast:6 row_mask:0xf bank_mask:0xf
  v_and_b32_dpp v54, v57, v82 row_newbcast:6 row_mask:0xf bank_mask:0xf
  v_and_b32_dpp v55, v57, v83 row_newbcast:6 row_mask:0xf bank_mask:0xf
  s_waitcnt vmcnt(9)
  v_mfma_f32_16x16x32_bf16 v[44:47], a[32:35], v[48:51], v[44:47]
  s_add_u32 s75, s74, 16384
  buffer_load_dwordx4 a[32:35], v4, s[36:39], s75 offen offset:0 nt
  v_and_b32_dpp v48, v57, v80 row_newbcast:10 row_mask:0xf bank_mask:0xf
  v_and_b32_dpp v49, v57, v81 row_newbcast:10 row_mask:0xf bank_mask:0xf
  v_and_b32_dpp v50, v57, v82 row_newbcast:10 row_mask:0xf bank_mask:0xf
  v_and_b32_dpp v51, v57, v83 row_newbcast:10 row_mask:0xf bank_mask:0xf
  s_waitcnt vmcnt(10)
  v_mfma_f32_16x16x32_bf16 v[44:47], a[36:39], v[52:55], v[44:47]
  buffer_load_dwordx4 a[36:39], v4, s[36:39], s75 offen offset:1024 nt
  v_and_b32_dpp v52, v57, v80 row_newbcast:14 row_mask:0xf bank_mask:0xf
  v_and_b32_dpp v53, v57, v81 row_newbcast:14 row_mask:0xf bank_mask:0xf
  v_and_b32_dpp v54, v57, v82 row_newbcast:14 row_mask:0xf bank_mask:0xf
  v_and_b32_dpp v55, v57, v83 row_newbcast:14 row_mask:0xf bank_mask:0xf
  s_waitcnt vmcnt(9)
  v_mfma_f32_16x16x32_bf16 v[44:47], a[40:43], v[48:51], v[44:47]
  s_add_u32 s75, s74, 24576
  buffer_load_dwordx4 a[40:43], v4, s[36:39], s75 offen offset:0 nt
  v_and_b32_dpp v48, v57, v80 row_newbcast:3 row_mask:0xf bank_mask:0xf
  v_and_b32_dpp v49, v57, v81 row_newbcast:3 row_mask:0xf bank_mask:0xf
  v_and_b32_dpp v50, v57, v82 row_newbcast:3 row_mask:0xf bank_mask:0xf
  v_and_b32_dpp v51, v57, v83 row_newbcast:3 row_mask:0xf bank_mask:0xf
  s_waitcnt vmcnt(10)
  v_mfma_f32_16x16x32_bf16 v[44:47], a[44:47], v[52:55], v[44:47]
  buffer_load_dwordx4 a[44:47], v4, s[36:39], s75 offen offset:1024 nt
  v_and_b32_dpp v52, v57, v80 row_newbcast:7 row_mask:0xf bank_mask:0xf
  v_and_b32_dpp v53, v57, v81 row_newbcast:7 row_mask:0xf bank_mask:0xf
  v_and_b32_dpp v54, v57, v82 row_newbcast:7 row_mask:0xf bank_mask:0xf
  v_and_b32_dpp v55, v57, v83 row_newbcast:7 row_mask:0xf bank_mask:0xf
  s_waitcnt vmcnt(9)
  v_mfma_f32_16x16x32_bf16 v[44:47], a[48:51], v[48:51], v[44:47]
  s_add_u32 s75, s74, 16384
  buffer_load_dwordx4 a[48:51], v4, s[36:39], s75 offen offset:2048 nt
  v_and_b32_dpp v48, v57, v80 row_newbcast:11 row_mask:0xf bank_mask:0xf
  v_and_b32_dpp v49, v57, v81 row_newbcast:11 row_mask:0xf bank_mask:0xf
  v_and_b32_dpp v50, v57, v82 row_newbcast:11 row_mask:0xf bank_mask:0xf
  v_and_b32_dpp v51, v57, v83 row_newbcast:11 row_mask:0xf bank_mask:0xf
  s_waitcnt vmcnt(10)
  v_mfma_f32_16x16x32_bf16 v[44:47], a[52:55], v[52:55], v[44:47]
  buffer_load_dwordx4 a[52:55], v4, s[36:39], s75 offen offset:3072 nt
  v_and_b32_dpp v52, v57, v80 row_newbcast:15 row_mask:0xf bank_mask:0xf
  v_and_b32_dpp v53, v57, v81 row_newbcast:15 row_mask:0xf bank_mask:0xf
  v_and_b32_dpp v54, v57, v82 row_newbcast:15 row_mask:0xf bank_mask:0xf
  v_and_b32_dpp v55, v57, v83 row_newbcast:15 row_mask:0xf bank_mask:0xf
  s_waitcnt vmcnt(9)
  v_mfma_f32_16x16x32_bf16 v[44:47], a[56:59], v[48:51], v[44:47]
  s_add_u32 s75, s74, 24576
  buffer_load_dwordx4 a[56:59], v4, s[36:39], s75 offen offset:2048 nt
  s_waitcnt vmcnt(10)
  v_mfma_f32_16x16x32_bf16 v[44:47], a[60:63], v[52:55], v[44:47]
  buffer_load_dwordx4 a[60:63], v4, s[36:39], s75 offen offset:3072 nt
  s_mov_b32 s74, s73
  s_bfe_u32 s58, s76, 393216
  s_lshl_b32 s58, s58, 18
  s_add_u32 s74, s74, s58
  s_add_u32 s76, s76, 1
  ds_read_b32 v79, v74 offset:288
  s_branch L_step
L_v2:
  v_and_b32_dpp v48, v57, v80 row_newbcast:0 row_mask:0xf bank_mask:0xf
  v_and_b32_dpp v49, v57, v81 row_newbcast:0 row_mask:0xf bank_mask:0xf
  v_and_b32_dpp v50, v57, v82 row_newbcast:0 row_mask:0xf bank_mask:0xf
  v_and_b32_dpp v51, v57, v83 row_newbcast:0 row_mask:0xf bank_mask:0xf
  v_and_b32_dpp v52, v57, v80 row_newbcast:4 row_mask:0xf bank_mask:0xf
  v_and_b32_dpp v53, v57, v81 row_newbcast:4 row_mask:0xf bank_mask:0xf
  v_and_b32_dpp v54, v57, v82 row_newbcast:4 row_mask:0xf bank_mask:0xf
  v_and_b32_dpp v55, v57, v83 row_newbcast:4 row_mask:0xf bank_mask:0xf
  s_waitcnt vmcnt(9)
  v_mfma_f32_16x16x32_bf16 v[44:47], a[0:3], v[48:51], v[44:47]
  buffer_load_dwordx4 a[0:3], v4, s[36:39], s74 offen offset:0 nt
  v_and_b32_dpp v48, v57, v80 row_newbcast:8 row_mask:0xf bank_mask:0xf
  v_and_b32_dpp v49, v57, v81 row_newbcast:8 row_mask:0xf bank_mask:0xf
  v_and_b32_dpp v50, v57, v82 row_newbcast:8 row_mask:0xf bank_mask:0xf
  v_and_b32_dpp v51, v57, v83 row_newbcast:8 row_mask:0xf bank_mask:0xf
  s_waitcnt vmcnt(9)
  v_mfma_f32_16x16x32_bf16 v[44:47], a[4:7], v[52:55], v[44:47]
  buffer_load_dwordx4 a[4:7], v4, s[36:39], s74 offen offset:1024 nt
  v_and_b32_dpp v52, v57, v80 row_newbcast:12 row_mask:0xf bank_mask:0xf
  v_and_b32_dpp v53, v57, v81 row_newbcast:12 row_mask:0xf bank_mask:0xf
  v_and_b32_dpp v54, v57, v82 row_newbcast:12 row_mask:0xf bank_mask:0xf
  v_and_b32_dpp v55, v57, v83 row_newbcast:12 row_mask:0xf bank_mask:0xf
  s_waitcnt vmcnt(9)
  v_mfma_f32_16x16x32_bf16 v[44:47], a[8:11], v[48:51], v[44:47]
  s_add_u32 s75, s74, 8192
  buffer_load_dwordx4 a[8:11], v4, s[36:39], s75 offen offset:0 nt
  v_and_b32_dpp v48, v57, v80 row_newbcast:1 row_mask:0xf bank_mask:0xf
  v_and_b32_dpp v49, v57, v81 row_newbcast:1 row_mask:0xf bank_mask:0xf
  v_and_b32_dpp v50, v57, v82 row_newbcast:1 row_mask:0xf bank_mask:0xf
  v_and_b32_dpp v51, v57, v83 row_newbcast:1 row_mask:0xf bank_mask:0xf
  s_waitcnt vmcnt(9)
  v_mfma_f32_16x16x32_bf16 v[44:47], a[12:15], v[52:55], v[44:47]
  buffer_load_dwordx4 a[12:15], v4, s[36:39], s75 offen offset:1024 nt
  v_and_b32_dpp v52, v57, v80 row_newbcast:5 row_mask:0xf bank_mask:0xf
  v_and_b32_dpp v53, v57, v81 row_newbcast:5 row_mask:0xf bank_mask:0xf
  v_and_b32_dpp v54, v57, v82 row_newbcast:5 row_mask:0xf bank_mask:0xf
  v_and_b32_dpp v55, v57, v83 row_newbcast:5 row_mask:0xf bank_mask:0xf
  s_waitcnt vmcnt(9)
  v_mfma_f32_16x16x32_bf16 v[44:47], a[16:19], v[48:51], v[44:47]
  buffer_load_dwordx4 a[16:19], v4, s[36:39], s74 offen offset:2048 nt
  v_and_b32_dpp v48, v57, v80 row_newbcast:9 row_mask:0xf bank_mask:0xf
  v_and_b32_dpp v49, v57, v81 row_newbcast:9 row_mask:0xf bank_mask:0xf
  v_and_b32_dpp v50, v57, v82 row_newbcast:9 row_mask:0xf bank_mask:0xf
  v_and_b32_dpp v51, v57, v83 row_newbcast:9 row_mask:0xf bank_mask:0xf
  s_waitcnt vmcnt(9)
  v_mfma_f32_16x16x32_bf16 v[44:47], a[20:23], v[52:55], v[44:47]
  buffer_load_dwordx4 a[20:23], v4, s[36:39], s74 offen offset:3072 nt
  v_and_b32_dpp v52, v57, v80 row_newbcast:13 row_mask:0xf bank_mask:0xf
  v_and_b32_dpp v53, v57, v81 row_newbcast:13 row_mask:0xf bank_mask:0xf
  v_and_b32_dpp v54, v57, v82 row_newbcast:13 row_mask:0xf bank_mask:0xf
  v_and_b32_dpp v55, v57, v83 row_newbcast:13 row_mask:0xf bank_mask:0xf
  s_waitcnt vmcnt(9)
  v_mfma_f32_16x16x32_bf16 v[44:47], a[24:27], v[48:51], v[44:47]
  s_add_u32 s75, s74, 8192
  buffer_load_dwordx4 a[24:27], v4, s[36:39], s75 offen offset:2048 nt
  v_and_b32_dpp v48, v57, v80 row_newbcast:2 row_mask:0xf bank_mask:0xf
  v_and_b32_dpp v49, v57, v81 row_newbcast:2 row_mask:0xf bank_mask:0xf
  v_and_b32_dpp v50, v57, v82 row_newbcast:2 row_mask:0xf bank_mask:0xf
  v_and_b32_dpp v51, v57, v83 row_newbcast:2 row_mask:0xf bank_mask:0xf
  s_waitcnt vmcnt(9)
  v_mfma_f32_16x16x32_bf16 v[44:47], a[28:31], v[52:55], v[44:47]
  buffer_load_dwordx4 a[28:31], v4, s[36:39], s75 offen offset:3072 nt
  v_and_b32_dpp v52, v57, v80 row_newbcast:6 row_mask:0xf bank_mask:0xf
  v_and_b32_dpp v53, v57, v81 row_newbcast:6 row_mask:0xf bank_mask:0xf
  v_and_b32_dpp v54, v57, v82 row_newbcast:6 row_mask:0xf bank_mask:0xf
  v_and_b32_dpp v55, v57, v83 row_newbcast:6 row_mask:0xf bank_mask:0xf
  s_waitcnt vmcnt(9)
  v_mfma_f32_16x16x32_bf16 v[44:47], a[32:35], v[48:51], v[44:47]
  s_add_u32 s75, s74, 16384
  buffer_load_dwordx4 a[32:35], v4, s[36:39], s75 offen offset:0 nt
  v_and_b32_dpp v48, v57, v80 row_newbcast:10 row_mask:0xf bank_mask:0xf
  v_and_b32_dpp v49, v57, v81 row_newbcast:10 row_mask:0xf bank_mask:0xf
  v_and_b32_dpp v50, v57, v82 row_newbcast:10 row_mask:0xf bank_mask:0xf
  v_and_b32_dpp v51, v57, v83 row_newbcast:10 row_mask:0xf bank_mask:0xf
  s_waitcnt vmcnt(9)
  v_mfma_f32_16x16x32_bf16 v[44:47], a[36:39], v[52:55], v[44:47]
  buffer_load_dwordx4 a[36:39], v4, s[36:39], s75 offen offset:1024 nt
  v_and_b32_dpp v52, v57, v80 row_newbcast:14 row_mask:0xf bank_mask:0xf
  v_and_b32_dpp v53, v57, v81 row_newbcast:14 row_mask:0xf bank_mask:0xf
  v_and_b32_dpp v54, v57, v82 row_newbcast:14 row_mask:0xf bank_mask:0xf
  v_and_b32_dpp v55, v57, v83 row_newbcast:14 row_mask:0xf bank_mask:0xf
  s_waitcnt vmcnt(9)
  v_mfma_f32_16x16x32_bf16 v[44:47], a[40:43], v[48:51], v[44:47]
  s_add_u32 s75, s74, 24576
  buffer_load_dwordx4 a[40:43], v4, s[36:39], s75 offen offset:0 nt
  v_and_b32_dpp v48, v57, v80 row_newbcast:3 row_mask:0xf bank_mask:0xf
  v_and_b32_dpp v49, v57, v81 row_newbcast:3 row_mask:0xf bank_mask:0xf
  v_and_b32_dpp v50, v57, v82 row_newbcast:3 row_mask:0xf bank_mask:0xf
  v_and_b32_dpp v51, v57, v83 row_newbcast:3 row_mask:0xf bank_mask:0xf
  s_waitcnt vmcnt(9)
  v_mfma_f32_16x16x32_bf16 v[44:47], a[44:47], v[52:55], v[44:47]
  buffer_load_dwordx4 a[44:47], v4, s[36:39], s75 offen offset:1024 nt
  v_and_b32_dpp v52, v57, v80 row_newbcast:7 row_mask:0xf bank_mask:0xf
  v_and_b32_dpp v53, v57, v81 row_newbcast:7 row_mask:0xf bank_mask:0xf
  v_and_b32_dpp v54, v57, v82 row_newbcast:7 row_mask:0xf bank_mask:0xf
  v_and_b32_dpp v55, v57, v83 row_newbcast:7 row_mask:0xf bank_mask:0xf
  s_waitcnt vmcnt(9)
  v_mfma_f32_16x16x32_bf16 v[44:47], a[48:51], v[48:51], v[44:47]
  s_add_u32 s75, s74, 16384
  buffer_load_dwordx4 a[48:51], v4, s[36:39], s75 offen offset:2048 nt
  v_and_b32_dpp v48, v57, v80 row_newbcast:11 row_mask:0xf bank_mask:0xf
  v_and_b32_dpp v49, v57, v81 row_newbcast:11 row_mask:0xf bank_mask:0xf
  v_and_b32_dpp v50, v57, v82 row_newbcast:11 row_mask:0xf bank_mask:0xf
  v_and_b32_dpp v51, v57, v83 row_newbcast:11 row_mask:0xf bank_mask:0xf
  s_waitcnt vmcnt(9)
  v_mfma_f32_16x16x32_bf16 v[44:47], a[52:55], v[52:55], v[44:47]
  buffer_load_dwordx4 a[52:55], v4, s[36:39], s75 offen offset:3072 nt
  v_and_b32_dpp v52, v57, v80 row_newbcast:15 row_mask:0xf bank_mask:0xf
  v_and_b32_dpp v53, v57, v81 row_newbcast:15 row_mask:0xf bank_mask:0xf
  v_and_b32_dpp v54, v57, v82 row_newbcast:15 row_mask:0xf bank_mask:0xf
  v_and_b32_dpp v55, v57, v83 row_newbcast:15 row_mask:0xf bank_mask:0xf
  s_waitcnt vmcnt(9)
  v_mfma_f32_16x16x32_bf16 v[44:47], a[56:59], v[48:51], v[44:47]
  s_add_u32 s75, s74, 24576
  buffer_load_dwordx4 a[56:59], v4, s[36:39], s75 offen offset:2048 nt
  s_waitcnt vmcnt(9)
  v_mfma_f32_16x16x32_bf16 v[44:47], a[60:63], v[52:55], v[44:47]
  buffer_load_dwordx4 a[60:63], v4, s[36:39], s75 offen offset:3072 nt
  s_mov_b32 s74, s73
  s_bfe_u32 s58, s76, 393216
  s_lshl_b32 s58, s58, 18
  s_add_u32 s74, s74, s58
  s_add_u32 s76, s76, 1
  ds_read_b32 v79, v74 offset:288
  s_branch L_step
L_v1:
  v_and_b32_dpp v48, v57, v80 row_newbcast:0 row_mask:0xf bank_mask:0xf
  v_and_b32_dpp v49, v57, v81 row_newbcast:0 row_mask:0xf bank_mask:0xf
  v_and_b32_dpp v50, v57, v82 row_newbcast:0 row_mask:0xf bank_mask:0xf
  v_and_b32_dpp v51, v57, v83 row_newbcast:0 row_mask:0xf bank_mask:0xf
  v_and_b32_dpp v52, v57, v80 row_newbcast:4 row_mask:0xf bank_mask:0xf
  v_and_b32_dpp v53, v57, v81 row_newbcast:4 row_mask:0xf bank_mask:0xf
  v_and_b32_dpp v54, v57, v82 row_newbcast:4 row_mask:0xf bank_mask:0xf
  v_and_b32_dpp v55, v57, v83 row_newbcast:4 row_mask:0xf bank_mask:0xf
  s_waitcnt vmcnt(8)
  v_mfma_f32_16x16x32_bf16 v[44:47], a[0:3], v[48:51], v[44:47]
  buffer_load_dwordx4 a[0:3], v4, s[36:39], s74 offen offset:0 nt
  v_and_b32_dpp v48, v57, v80 row_newbcast:8 row_mask:0xf bank_mask:0xf
  v_and_b32_dpp v49, v57, v81 row_newbcast:8 row_mask:0xf bank_mask:0xf
  v_and_b32_dpp v50, v57, v82 row_newbcast:8 row_mask:0xf bank_mask:0xf
  v_and_b32_dpp v51, v57, v83 row_newbcast:8 row_mask:0xf bank_mask:0xf
  s_waitcnt vmcnt(9)
  v_mfma_f32_16x16x32_bf16 v[44:47], a[4:7], v[52:55], v[44:47]
  buffer_load_dwordx4 a[4:7], v4, s[36:39], s74 offen offset:1024 nt
  v_and_b32_dpp v52, v57, v80 row_newbcast:12 row_mask:0xf bank_mask:0xf
  v_and_b32_dpp v53, v57, v81 row_newbcast:12 row_mask:0xf bank_mask:0xf
  v_and_b32_dpp v54, v57, v82 row_newbcast:12 row_mask:0xf bank_mask:0xf
  v_and_b32_dpp v55, v57, v83 row_newbcast:12 row_mask:0xf bank_mask:0xf
  s_waitcnt vmcnt(8)
  v_mfma_f32_16x16x32_bf16 v[44:47], a[8:11], v[48:51], v[44:47]
  s_add_u32 s75, s74, 8192
  buffer_load_dwordx4 a[8:11], v4, s[36:39], s75 offen offset:0 nt
  v_and_b32_dpp v48, v57, v80 row_newbcast:1 row_mask:0xf bank_mask:0xf
  v_and_b32_dpp v49, v57, v81 row_newbcast:1 row_mask:0xf bank_mask:0xf
  v_and_b32_dpp v50, v57, v82 row_newbcast:1 row_mask:0xf bank_mask:0xf
  v_and_b32_dpp v51, v57, v83 row_newbcast:1 row_mask:0xf bank_mask:0xf
  s_waitcnt vmcnt(9)
  v_mfma_f32_16x16x32_bf16 v[44:47], a[12:15], v[52:55], v[44:47]
  buffer_load_dwordx4 a[12:15], v4, s[36:39], s75 offen offset:1024 nt
  v_and_b32_dpp v52, v57, v80 row_newbcast:5 row_mask:0xf bank_mask:0xf
  v_and_b32_dpp v53, v57, v81 row_newbcast:5 row_mask:0xf bank_mask:0xf
  v_and_b32_dpp v54, v57, v82 row_newbcast:5 row_mask:0xf bank_mask:0xf
  v_and_b32_dpp v55, v57, v83 row_newbcast:5 row_mask:0xf bank_mask:0xf
  s_waitcnt vmcnt(8)
  v_mfma_f32_16x16x32_bf16 v[44:47], a[16:19], v[48:51], v[44:47]
  buffer_load_dwordx4 a[16:19], v4, s[36:39], s74 offen offset:2048 nt
  v_and_b32_dpp v48, v57, v80 row_newbcast:9 row_mask:0xf bank_mask:0xf
  v_and_b32_dpp v49, v57, v81 row_newbcast:9 row_mask:0xf bank_mask:0xf
  v_and_b32_dpp v50, v57, v82 row_newbcast:9 row_mask:0xf bank_mask:0xf
  v_and_b32_dpp v51, v57, v83 row_newbcast:9 row_mask:0xf bank_mask:0xf
  s_waitcnt vmcnt(9)
  v_mfma_f32_16x16x32_bf16 v[44:47], a[20:23], v[52:55], v[44:47]
  buffer_load_dwordx4 a[20:23], v4, s[36:39], s74 offen offset:3072 nt
  v_and_b32_dpp v52, v57, v80 row_newbcast:13 row_mask:0xf bank_mask:0xf
  v_and_b32_dpp v53, v57, v81 row_newbcast:13 row_mask:0xf bank_mask:0xf
  v_and_b32_dpp v54, v57, v82 row_newbcast:13 row_mask:0xf bank_mask:0xf
  v_and_b32_dpp v55, v57, v83 row_newbcast:13 row_mask:0xf bank_mask:0xf
  s_waitcnt vmcnt(8)
  v_mfma_f32_16x16x32_bf16 v[44:47], a[24:27], v[48:51], v[44:47]
  s_add_u32 s75, s74, 8192
  buffer_load_dwordx4 a[24:27], v4, s[36:39], s75 offen offset:2048 nt
  v_and_b32_dpp v48, v57, v80 row_newbcast:2 row_mask:0xf bank_mask:0xf
  v_and_b32_dpp v49, v57, v81 row_newbcast:2 row_mask:0xf bank_mask:0xf
  v_and_b32_dpp v50, v57, v82 row_newbcast:2 row_mask:0xf bank_mask:0xf
  v_and_b32_dpp v51, v57, v83 row_newbcast:2 row_mask:0xf bank_mask:0xf
  s_waitcnt vmcnt(9)
  v_mfma_f32_16x16x32_bf16 v[44:47], a[28:31], v[52:55], v[44:47]
  buffer_load_dwordx4 a[28:31], v4, s[36:39], s75 offen offset:3072 nt
  v_and_b32_dpp v52, v57, v80 row_newbcast:6 row_mask:0xf bank_mask:0xf
  v_and_b32_dpp v53, v57, v81 row_newbcast:6 row_mask:0xf bank_mask:0xf
  v_and_b32_dpp v54, v57, v82 row_newbcast:6 row_mask:0xf bank_mask:0xf
  v_and_b32_dpp v55, v57, v83 row_newbcast:6 row_mask:0xf bank_mask:0xf
  s_waitcnt vmcnt(8)
  v_mfma_f32_16x16x32_bf16 v[44:47], a[32:35], v[48:51], v[44:47]
  s_add_u32 s75, s74, 16384
  buffer_load_dwordx4 a[32:35], v4, s[36:39], s75 offen offset:0 nt
  v_and_b32_dpp v48, v57, v80 row_newbcast:10 row_mask:0xf bank_mask:0xf
  v_and_b32_dpp v49, v57, v81 row_newbcast:10 row_mask:0xf bank_mask:0xf
  v_and_b32_dpp v50, v57, v82 row_newbcast:10 row_mask:0xf bank_mask:0xf
  v_and_b32_dpp v51, v57, v83 row_newbcast:10 row_mask:0xf bank_mask:0xf
  s_waitcnt vmcnt(9)
  v_mfma_f32_16x16x32_bf16 v[44:47], a[36:39], v[52:55], v[44:47]
  buffer_load_dwordx4 a[36:39], v4, s[36:39], s75 offen offset:1024 nt
  v_and_b32_dpp v52, v57, v80 row_newbcast:14 row_mask:0xf bank_mask:0xf
  v_and_b32_dpp v53, v57, v81 row_newbcast:14 row_mask:0xf bank_mask:0xf
  v_and_b32_dpp v54, v57, v82 row_newbcast:14 row_mask:0xf bank_mask:0xf
  v_and_b32_dpp v55, v57, v83 row_newbcast:14 row_mask:0xf bank_mask:0xf
  s_waitcnt vmcnt(8)
  v_mfma_f32_16x16x32_bf16 v[44:47], a[40:43], v[48:51], v[44:47]
  s_add_u32 s75, s74, 24576
  buffer_load_dwordx4 a[40:43], v4, s[36:39], s75 offen offset:0 nt
  v_and_b32_dpp v48, v57, v80 row_newbcast:3 row_mask:0xf bank_mask:0xf
  v_and_b32_dpp v49, v57, v81 row_newbcast:3 row_mask:0xf bank_mask:0xf
  v_and_b32_dpp v50, v57, v82 row_newbcast:3 row_mask:0xf bank_mask:0xf
  v_and_b32_dpp v51, v57, v83 row_newbcast:3 row_mask:0xf bank_mask:0xf
  s_waitcnt vmcnt(9)
  v_mfma_f32_16x16x32_bf16 v[44:47], a[44:47], v[52:55], v[44:47]
  buffer_load_dwordx4 a[44:47], v4, s[36:39], s75 offen offset:1024 nt
  v_and_b32_dpp v52, v57, v80 row_newbcast:7 row_mask:0xf bank_mask:0xf
  v_and_b32_dpp v53, v57, v81 row_newbcast:7 row_mask:0xf bank_mask:0xf
  v_and_b32_dpp v54, v57, v82 row_newbcast:7 row_mask:0xf bank_mask:0xf
  v_and_b32_dpp v55, v57, v83 row_newbcast:7 row_mask:0xf bank_mask:0xf
  s_waitcnt vmcnt(8)
  v_mfma_f32_16x16x32_bf16 v[44:47], a[48:51], v[48:51], v[44:47]
  s_add_u32 s75, s74, 16384
  buffer_load_dwordx4 a[48:51], v4, s[36:39], s75 offen offset:2048 nt
  v_and_b32_dpp v48, v57, v80 row_newbcast:11 row_mask:0xf bank_mask:0xf
  v_and_b32_dpp v49, v57, v81 row_newbcast:11 row_mask:0xf bank_mask:0xf
  v_and_b32_dpp v50, v57, v82 row_newbcast:11 row_mask:0xf bank_mask:0xf
  v_and_b32_dpp v51, v57, v83 row_newbcast:11 row_mask:0xf bank_mask:0xf
  s_waitcnt vmcnt(9)
  v_mfma_f32_16x16x32_bf16 v[44:47], a[52:55], v[52:55], v[44:47]
  buffer_load_dwordx4 a[52:55], v4, s[36:39], s75 offen offset:3072 nt
  v_and_b32_dpp v52, v57, v80 row_newbcast:15 row_mask:0xf bank_mask:0xf
  v_and_b32_dpp v53, v57, v81 row_newbcast:15 row_mask:0xf bank_mask:0xf
  v_and_b32_dpp v54, v57, v82 row_newbcast:15 row_mask:0xf bank_mask:0xf
  v_and_b32_dpp v55, v57, v83 row_newbcast:15 row_mask:0xf bank_mask:0xf
  s_waitcnt vmcnt(8)
  v_mfma_f32_16x16x32_bf16 v[44:47], a[56:59], v[48:51], v[44:47]
  s_add_u32 s75, s74, 24576
  buffer_load_dwordx4 a[56:59], v4, s[36:39], s75 offen offset:2048 nt
  s_waitcnt vmcnt(9)
  v_mfma_f32_16x16x32_bf16 v[44:47], a[60:63], v[52:55], v[44:47]
  buffer_load_dwordx4 a[60:63], v4, s[36:39], s75 offen offset:3072 nt
  s_mov_b32 s74, s73
  s_bfe_u32 s58, s76, 393216
  s_lshl_b32 s58, s58, 18
  s_add_u32 s74, s74, s58
  s_add_u32 s76, s76, 1
  ds_read_b32 v79, v74 offset:288
  s_branch L_step
L_v0:
  v_and_b32_dpp v48, v57, v80 row_newbcast:0 row_mask:0xf bank_mask:0xf
  v_and_b32_dpp v49, v57, v81 row_newbcast:0 row_mask:0xf bank_mask:0xf
  v_and_b32_dpp v50, v57, v82 row_newbcast:0 row_mask:0xf bank_mask:0xf
  v_and_b32_dpp v51, v57, v83 row_newbcast:0 row_mask:0xf bank_mask:0xf
  v_and_b32_dpp v52, v57, v80 row_newbcast:4 row_mask:0xf bank_mask:0xf
  v_and_b32_dpp v53, v57, v81 row_newbcast:4 row_mask:0xf bank_mask:0xf
  v_and_b32_dpp v54, v57, v82 row_newbcast:4 row_mask:0xf bank_mask:0xf
  v_and_b32_dpp v55, v57, v83 row_newbcast:4 row_mask:0xf bank_mask:0xf
  s_waitcnt vmcnt(8)
  v_mfma_f32_16x16x32_bf16 v[44:47], a[0:3], v[48:51], v[44:47]
  buffer_load_dwordx4 a[0:3], v4, s[36:39], s74 offen offset:0 nt
  v_and_b32_dpp v48, v57, v80 row_newbcast:8 row_mask:0xf bank_mask:0xf
  v_and_b32_dpp v49, v57, v81 row_newbcast:8 row_mask:0xf bank_mask:0xf
  v_and_b32_dpp v50, v57, v82 row_newbcast:8 row_mask:0xf bank_mask:0xf
  v_and_b32_dpp v51, v57, v83 row_newbcast:8 row_mask:0xf bank_mask:0xf
  s_waitcnt vmcnt(8)
  v_mfma_f32_16x16x32_bf16 v[44:47], a[4:7], v[52:55], v[44:47]
  buffer_load_dwordx4 a[4:7], v4, s[36:39], s74 offen offset:1024 nt
  v_and_b32_dpp v52, v57, v80 row_newbcast:12 row_mask:0xf bank_mask:0xf
  v_and_b32_dpp v53, v57, v81 row_newbcast:12 row_mask:0xf bank_mask:0xf
  v_and_b32_dpp v54, v57, v82 row_newbcast:12 row_mask:0xf bank_mask:0xf
  v_and_b32_dpp v55, v57, v83 row_newbcast:12 row_mask:0xf bank_mask:0xf
  s_waitcnt vmcnt(8)
  v_mfma_f32_16x16x32_bf16 v[44:47], a[8:11], v[48:51], v[44:47]
  s_add_u32 s75, s74, 8192
  buffer_load_dwordx4 a[8:11], v4, s[36:39], s75 offen offset:0 nt
  v_and_b32_dpp v48, v57, v80 row_newbcast:1 row_mask:0xf bank_mask:0xf
  v_and_b32_dpp v49, v57, v81 row_newbcast:1 row_mask:0xf bank_mask:0xf
  v_and_b32_dpp v50, v57, v82 row_newbcast:1 row_mask:0xf bank_mask:0xf
  v_and_b32_dpp v51, v57, v83 row_newbcast:1 row_mask:0xf bank_mask:0xf
  s_waitcnt vmcnt(8)
  v_mfma_f32_16x16x32_bf16 v[44:47], a[12:15], v[52:55], v[44:47]
  buffer_load_dwordx4 a[12:15], v4, s[36:39], s75 offen offset:1024 nt
  v_and_b32_dpp v52, v57, v80 row_newbcast:5 row_mask:0xf bank_mask:0xf
  v_and_b32_dpp v53, v57, v81 row_newbcast:5 row_mask:0xf bank_mask:0xf
  v_and_b32_dpp v54, v57, v82 row_newbcast:5 row_mask:0xf bank_mask:0xf
  v_and_b32_dpp v55, v57, v83 row_newbcast:5 row_mask:0xf bank_mask:0xf
  s_waitcnt vmcnt(8)
  v_mfma_f32_16x16x32_bf16 v[44:47], a[16:19], v[48:51], v[44:47]
  buffer_load_dwordx4 a[16:19], v4, s[36:39], s74 offen offset:2048 nt
  v_and_b32_dpp v48, v57, v80 row_newbcast:9 row_mask:0xf bank_mask:0xf
  v_and_b32_dpp v49, v57, v81 row_newbcast:9 row_mask:0xf bank_mask:0xf
  v_and_b32_dpp v50, v57, v82 row_newbcast:9 row_mask:0xf bank_mask:0xf
  v_and_b32_dpp v51, v57, v83 row_newbcast:9 row_mask:0xf bank_mask:0xf
  s_waitcnt vmcnt(8)
  v_mfma_f32_16x16x32_bf16 v[44:47], a[20:23], v[52:55], v[44:47]
  buffer_load_dwordx4 a[20:23], v4, s[36:39], s74 offen offset:3072 nt
  v_and_b32_dpp v52, v57, v80 row_newbcast:13 row_mask:0xf bank_mask:0xf
  v_and_b32_dpp v53, v57, v81 row_newbcast:13 row_mask:0xf bank_mask:0xf
  v_and_b32_dpp v54, v57, v82 row_newbcast:13 row_mask:0xf bank_mask:0xf
  v_and_b32_dpp v55, v57, v83 row_newbcast:13 row_mask:0xf bank_mask:0xf
  s_waitcnt vmcnt(8)
  v_mfma_f32_16x16x32_bf16 v[44:47], a[24:27], v[48:51], v[44:47]
  s_add_u32 s75, s74, 8192
  buffer_load_dwordx4 a[24:27], v4, s[36:39], s75 offen offset:2048 nt
  v_and_b32_dpp v48, v57, v80 row_newbcast:2 row_mask:0xf bank_mask:0xf
  v_and_b32_dpp v49, v57, v81 row_newbcast:2 row_mask:0xf bank_mask:0xf
  v_and_b32_dpp v50, v57, v82 row_newbcast:2 row_mask:0xf bank_mask:0xf
  v_and_b32_dpp v51, v57, v83 row_newbcast:2 row_mask:0xf bank_mask:0xf
  s_waitcnt vmcnt(8)
  v_mfma_f32_16x16x32_bf16 v[44:47], a[28:31], v[52:55], v[44:47]
  buffer_load_dwordx4 a[28:31], v4, s[36:39], s75 offen offset:3072 nt
  v_and_b32_dpp v52, v57, v80 row_newbcast:6 row_mask:0xf bank_mask:0xf
  v_and_b32_dpp v53, v57, v81 row_newbcast:6 row_mask:0xf bank_mask:0xf
  v_and_b32_dpp v54, v57, v82 row_newbcast:6 row_mask:0xf bank_mask:0xf
  v_and_b32_dpp v55, v57, v83 row_newbcast:6 row_mask:0xf bank_mask:0xf
  s_waitcnt vmcnt(8)
  v_mfma_f32_16x16x32_bf16 v[44:47], a[32:35], v[48:51], v[44:47]
  s_add_u32 s75, s74, 16384
  buffer_load_dwordx4 a[32:35], v4, s[36:39], s75 offen offset:0 nt
  v_and_b32_dpp v48, v57, v80 row_newbcast:10 row_mask:0xf bank_mask:0xf
  v_and_b32_dpp v49, v57, v81 row_newbcast:10 row_mask:0xf bank_mask:0xf
  v_and_b32_dpp v50, v57, v82 row_newbcast:10 row_mask:0xf bank_mask:0xf
  v_and_b32_dpp v51, v57, v83 row_newbcast:10 row_mask:0xf bank_mask:0xf
  s_waitcnt vmcnt(8)
  v_mfma_f32_16x16x32_bf16 v[44:47], a[36:39], v[52:55], v[44:47]
  buffer_load_dwordx4 a[36:39], v4, s[36:39], s75 offen offset:1024 nt
  v_and_b32_dpp v52, v57, v80 row_newbcast:14 row_mask:0xf bank_mask:0xf
  v_and_b32_dpp v53, v57, v81 row_newbcast:14 row_mask:0xf bank_mask:0xf
  v_and_b32_dpp v54, v57, v82 row_newbcast:14 row_mask:0xf bank_mask:0xf
  v_and_b32_dpp v55, v57, v83 row_newbcast:14 row_mask:0xf bank_mask:0xf
  s_waitcnt vmcnt(8)
  v_mfma_f32_16x16x32_bf16 v[44:47], a[40:43], v[48:51], v[44:47]
  s_add_u32 s75, s74, 24576
  buffer_load_dwordx4 a[40:43], v4, s[36:39], s75 offen offset:0 nt
  v_and_b32_dpp v48, v57, v80 row_newbcast:3 row_mask:0xf bank_mask:0xf
  v_and_b32_dpp v49, v57, v81 row_newbcast:3 row_mask:0xf bank_mask:0xf
  v_and_b32_dpp v50, v57, v82 row_newbcast:3 row_mask:0xf bank_mask:0xf
  v_and_b32_dpp v51, v57, v83 row_newbcast:3 row_mask:0xf bank_mask:0xf
  s_waitcnt vmcnt(8)
  v_mfma_f32_16x16x32_bf16 v[44:47], a[44:47], v[52:55], v[44:47]
  buffer_load_dwordx4 a[44:47], v4, s[36:39], s75 offen offset:1024 nt
  v_and_b32_dpp v52, v57, v80 row_newbcast:7 row_mask:0xf bank_mask:0xf
  v_and_b32_dpp v53, v57, v81 row_newbcast:7 row_mask:0xf bank_mask:0xf
  v_and_b32_dpp v54, v57, v82 row_newbcast:7 row_mask:0xf bank_mask:0xf
  v_and_b32_dpp v55, v57, v83 row_newbcast:7 row_mask:0xf bank_mask:0xf
  s_waitcnt vmcnt(8)
  v_mfma_f32_16x16x32_bf16 v[44:47], a[48:51], v[48:51], v[44:47]
  s_add_u32 s75, s74, 16384
  buffer_load_dwordx4 a[48:51], v4, s[36:39], s75 offen offset:2048 nt
  v_and_b32_dpp v48, v57, v80 row_newbcast:11 row_mask:0xf bank_mask:0xf
  v_and_b32_dpp v49, v57, v81 row_newbcast:11 row_mask:0xf bank_mask:0xf
  v_and_b32_dpp v50, v57, v82 row_newbcast:11 row_mask:0xf bank_mask:0xf
  v_and_b32_dpp v51, v57, v83 row_newbcast:11 row_mask:0xf bank_mask:0xf
  s_waitcnt vmcnt(8)
  v_mfma_f32_16x16x32_bf16 v[44:47], a[52:55], v[52:55], v[44:47]
  buffer_load_dwordx4 a[52:55], v4, s[36:39], s75 offen offset:3072 nt
  v_and_b32_dpp v52, v57, v80 row_newbcast:15 row_mask:0xf bank_mask:0xf
  v_and_b32_dpp v53, v57, v81 row_newbcast:15 row_mask:0xf bank_mask:0xf
  v_and_b32_dpp v54, v57, v82 row_newbcast:15 row_mask:0xf bank_mask:0xf
  v_and_b32_dpp v55, v57, v83 row_newbcast:15 row_mask:0xf bank_mask:0xf
  s_waitcnt vmcnt(8)
  v_mfma_f32_16x16x32_bf16 v[44:47], a[56:59], v[48:51], v[44:47]
  s_add_u32 s75, s74, 24576
  buffer_load_dwordx4 a[56:59], v4, s[36:39], s75 offen offset:2048 nt
  s_waitcnt vmcnt(8)
  v_mfma_f32_16x16x32_bf16 v[44:47], a[60:63], v[52:55], v[44:47]
  buffer_load_dwordx4 a[60:63], v4, s[36:39], s75 offen offset:3072 nt
  s_mov_b32 s74, s73
  s_bfe_u32 s58, s76, 393216
  s_lshl_b32 s58, s58, 18
  s_add_u32 s74, s74, s58
  s_add_u32 s76, s76, 1
  ds_read_b32 v79, v74 offset:288
  s_branch L_step
F_newrun:
  s_cmp_ge_u32 s68, 2
  s_cbranch_scc1 L_nr_drain
  s_mov_b32 s70, 1600000
L_lw11:
  ds_read_b32 v60, v73 offset:260
  s_waitcnt lgkmcnt(0)
  v_readfirstlane_b32 s58, v60
  s_nop 0
  s_cmp_ge_u32 s58, 1
  s_cbranch_scc1 L_lw11_ok
  s_sub_u32 s70, s70, 1
  s_cmp_eq_u32 s70, 0
  s_cbranch_scc1 L_lw11_ok
  s_sleep 1
  s_branch L_lw11
L_lw11_ok:
  s_mov_b32 s68, 2
  s_mov_b32 s69, 64
  s_mov_b32 s71, s46
  s_mov_b32 s36, s40
  s_mov_b32 s37, s41
  v_mov_b32 v4, v3
  s_lshl_b32 s47, s48, 1
  s_add_u32 s47, s47, s72
  s_lshl_b32 s47, s47, 17
  s_lshl_b32 s58, s49, 8
  s_add_u32 s47, s47, s58
  s_lshl_b32 s4, s2, 9
  s_add_u32 s4, s4, 589824
  s_lshl_b32 s5, s48, 12
  s_add_u32 s5, s5, 589824
  s_lshl_b32 s7, s49, 5
  s_add_u32 s7, s7, s48
  s_lshl_b32 s58, s72, 8
  s_add_u32 s7, s7, s58
  s_lshl_b32 s7, s7, 9
  s_add_u32 s7, s7, 851968
  s_add_u32 s8, s7, 1048576
  s_setpc_b64 s[80:81]
L_nr_drain:
  s_mov_b32 s36, s12
  s_mov_b32 s37, s13
  s_mov_b32 s38, s11
  s_mov_b32 s68, 4
  s_mov_b32 s69, 64
  s_setpc_b64 s[80:81]
F_update:
  s_nop 7
  v_mov_b32 v59, v56
  s_nop 1
  v_max_f32_dpp v59, v59, v59 row_ror:8 row_mask:0xf bank_mask:0xf
  s_nop 1
  v_max_f32_dpp v59, v59, v59 row_ror:4 row_mask:0xf bank_mask:0xf
  s_nop 1
  v_max_f32_dpp v59, v59, v59 row_ror:2 row_mask:0xf bank_mask:0xf
  s_nop 1
  v_max_f32_dpp v59, v59, v59 row_ror:1 row_mask:0xf bank_mask:0xf
  v_mov_b32 v60, v59
  s_nop 1
  v_permlane16_swap_b32 v59, v60
  v_max_f32 v59, v59, v60
  v_mov_b32 v60, v59
  s_nop 1
  v_permlane32_swap_b32 v59, v60
  v_max_f32 v59, v59, v60
  v_sub_f32 v60, v7, v59
  v_mul_f32 v60, 1069066811, v60
  v_exp_f32 v60, v60
  v_mov_b32 v7, v59
  v_mul_f32 v44, v44, v60
  v_mul_f32 v45, v45, v60
  v_mul_f32 v46, v46, v60
  v_mul_f32 v47, v47, v60
  s_nop 1
  s_setpc_b64 s[80:81]
L_vlast:
  s_mov_b32 s70, 1600000
L_lw12:
  ds_read_b32 v60, v73 offset:276
  s_waitcnt lgkmcnt(0)
  v_readfirstlane_b32 s58, v60
  s_nop 0
  s_cmp_ge_u32 s58, 1
  s_cbranch_scc1 L_lw12_ok
  s_sub_u32 s70, s70, 1
  s_cmp_eq_u32 s70, 0
  s_cbranch_scc1 L_lw12_ok
  s_branch L_lw12
L_lw12_ok:
  ds_read_b32 v68, v73 offset:272
  v_and_b32_dpp v48, v57, v80 row_newbcast:0 row_mask:0xf bank_mask:0xf
  v_and_b32_dpp v49, v57, v81 row_newbcast:0 row_mask:0xf bank_mask:0xf
  v_and_b32_dpp v50, v57, v82 row_newbcast:0 row_mask:0xf bank_mask:0xf
  v_and_b32_dpp v51, v57, v83 row_newbcast:0 row_mask:0xf bank_mask:0xf
  v_and_b32_dpp v52, v57, v80 row_newbcast:4 row_mask:0xf bank_mask:0xf
  v_and_b32_dpp v53, v57, v81 row_newbcast:4 row_mask:0xf bank_mask:0xf
  v_and_b32_dpp v54, v57, v82 row_newbcast:4 row_mask:0xf bank_mask:0xf
  v_and_b32_dpp v55, v57, v83 row_newbcast:4 row_mask:0xf bank_mask:0xf
  s_waitcnt vmcnt(7)
  v_mfma_f32_16x16x32_bf16 v[44:47], a[0:3], v[48:51], v[44:47]
  s_add_u32 s58, s47, 0
  buffer_load_dwordx4 a[64:67], v75, s[36:39], s58 offen nt
  v_and_b32_dpp v48, v57, v80 row_newbcast:8 row_mask:0xf bank_mask:0xf
  v_and_b32_dpp v49, v57, v81 row_newbcast:8 row_mask:0xf bank_mask:0xf
  v_and_b32_dpp v50, v57, v82 row_newbcast:8 row_mask:0xf bank_mask:0xf
  v_and_b32_dpp v51, v57, v83 row_newbcast:8 row_mask:0xf bank_mask:0xf
  s_waitcnt vmcnt(7)
  v_mfma_f32_16x16x32_bf16 v[44:47], a[4:7], v[52:55], v[44:47]
  s_add_u32 s58, s47, 2048
  buffer_load_dwordx4 a[68:71], v75, s[36:39], s58 offen nt
  v_and_b32_dpp v52, v57, v80 row_newbcast:12 row_mask:0xf bank_mask:0xf
  v_and_b32_dpp v53, v57, v81 row_newbcast:12 row_mask:0xf bank_mask:0xf
  v_and_b32_dpp v54, v57, v82 row_newbcast:12 row_mask:0xf bank_mask:0xf
  v_and_b32_dpp v55, v57, v83 row_newbcast:12 row_mask:0xf bank_mask:0xf
  s_waitcnt vmcnt(7)
  v_mfma_f32_16x16x32_bf16 v[44:47], a[8:11], v[48:51], v[44:47]
  s_add_u32 s58, s47, 4096
  buffer_load_dwordx4 a[72:75], v75, s[36:39], s58 offen nt
  s_waitcnt lgkmcnt(0)
  v_mov_b32 v62, 1069066811
  v_fma_f32 v68, v7, v62, -v68
  v_exp_f32 v68, v68
  v_and_b32_dpp v48, v57, v80 row_newbcast:1 row_mask:0xf bank_mask:0xf
  v_and_b32_dpp v49, v57, v81 row_newbcast:1 row_mask:0xf bank_mask:0xf
  v_and_b32_dpp v50, v57, v82 row_newbcast:1 row_mask:0xf bank_mask:0xf
  v_and_b32_dpp v51, v57, v83 row_newbcast:1 row_mask:0xf bank_mask:0xf
  s_waitcnt vmcnt(7)
  v_mfma_f32_16x16x32_bf16 v[44:47], a[12:15], v[52:55], v[44:47]
  s_add_u32 s58, s47, 6144
  buffer_load_dwordx4 a[76:79], v75, s[36:39], s58 offen nt
  v_and_b32_dpp v52, v57, v80 row_newbcast:5 row_mask:0xf bank_mask:0xf
  v_and_b32_dpp v53, v57, v81 row_newbcast:5 row_mask:0xf bank_mask:0xf
  v_and_b32_dpp v54, v57, v82 row_newbcast:5 row_mask:0xf bank_mask:0xf
  v_and_b32_dpp v55, v57, v83 row_newbcast:5 row_mask:0xf bank_mask:0xf
  s_waitcnt vmcnt(7)
  v_mfma_f32_16x16x32_bf16 v[44:47], a[16:19], v[48:51], v[44:47]
  s_add_u32 s58, s47, 8192
  buffer_load_dwordx4 a[80:83], v75, s[36:39], s58 offen nt
  v_and_b32_dpp v48, v57, v80 row_newbcast:9 row_mask:0xf bank_mask:0xf
  v_and_b32_dpp v49, v57, v81 row_newbcast:9 row_mask:0xf bank_mask:0xf
  v_and_b32_dpp v50, v57, v82 row_newbcast:9 row_mask:0xf bank_mask:0xf
  v_and_b32_dpp v51, v57, v83 row_newbcast:9 row_mask:0xf bank_mask:0xf
  s_waitcnt vmcnt(7)
  v_mfma_f32_16x16x32_bf16 v[44:47], a[20:23], v[52:55], v[44:47]
  s_add_u32 s58, s47, 10240
  buffer_load_dwordx4 a[84:87], v75, s[36:39], s58 offen nt
  v_and_b32_dpp v52, v57, v80 row_newbcast:13 row_mask:0xf bank_mask:0xf
  v_and_b32_dpp v53, v57, v81 row_newbcast:13 row_mask:0xf bank_mask:0xf
  v_and_b32_dpp v54, v57, v82 row_newbcast:13 row_mask:0xf bank_mask:0xf
  v_and_b32_dpp v55, v57, v83 row_newbcast:13 row_mask:0xf bank_mask:0xf
  s_waitcnt vmcnt(7)
  v_mfma_f32_16x16x32_bf16 v[44:47], a[24:27], v[48:51], v[44:47]
  s_add_u32 s58, s47, 12288
  buffer_load_dwordx4 a[88:91], v75, s[36:39], s58 offen nt
  v_and_b32_dpp v48, v57, v80 row_newbcast:2 row_mask:0xf bank_mask:0xf
  v_and_b32_dpp v49, v57, v81 row_newbcast:2 row_mask:0xf bank_mask:0xf
  v_and_b32_dpp v50, v57, v82 row_newbcast:2 row_mask:0xf bank_mask:0xf
  v_and_b32_dpp v51, v57, v83 row_newbcast:2 row_mask:0xf bank_mask:0xf
  s_waitcnt vmcnt(7)
  v_mfma_f32_16x16x32_bf16 v[44:47], a[28:31], v[52:55], v[44:47]
  s_add_u32 s58, s47, 14336
  buffer_load_dwordx4 a[92:95], v75, s[36:39], s58 offen nt
  v_and_b32_dpp v52, v57, v80 row_newbcast:6 row_mask:0xf bank_mask:0xf
  v_and_b32_dpp v53, v57, v81 row_newbcast:6 row_mask:0xf bank_mask:0xf
  v_and_b32_dpp v54, v57, v82 row_newbcast:6 row_mask:0xf bank_mask:0xf
  v_and_b32_dpp v55, v57, v83 row_newbcast:6 row_mask:0xf bank_mask:0xf
  s_waitcnt vmcnt(8)
  v_mfma_f32_16x16x32_bf16 v[44:47], a[32:35], v[48:51], v[44:47]
  s_add_u32 s58, s47, 65536
  buffer_load_dwordx4 a[96:99], v75, s[36:39], s58 offen nt
  ds_add_u32 v73, v69 offset:296
  v_and_b32_dpp v48, v57, v80 row_newbcast:10 row_mask:0xf bank_mask:0xf
  v_and_b32_dpp v49, v57, v81 row_newbcast:10 row_mask:0xf bank_mask:0xf
  v_and_b32_dpp v50, v57, v82 row_newbcast:10 row_mask:0xf bank_mask:0xf
  v_and_b32_dpp v51, v57, v83 row_newbcast:10 row_mask:0xf bank_mask:0xf
  s_waitcnt vmcnt(9)
  v_mfma_f32_16x16x32_bf16 v[44:47], a[36:39], v[52:55], v[44:47]
  s_add_u32 s58, s47, 67584
  buffer_load_dwordx4 a[100:103], v75, s[36:39], s58 offen nt
  v_and_b32_dpp v52, v57, v80 row_newbcast:14 row_mask:0xf bank_mask:0xf
  v_and_b32_dpp v53, v57, v81 row_newbcast:14 row_mask:0xf bank_mask:0xf
  v_and_b32_dpp v54, v57, v82 row_newbcast:14 row_mask:0xf bank_mask:0xf
  v_and_b32_dpp v55, v57, v83 row_newbcast:14 row_mask:0xf bank_mask:0xf
  s_waitcnt vmcnt(10)
  v_mfma_f32_16x16x32_bf16 v[44:47], a[40:43], v[48:51], v[44:47]
  s_add_u32 s58, s47, 69632
  buffer_load_dwordx4 a[104:107], v75, s[36:39], s58 offen nt
  v_and_b32_dpp v48, v57, v80 row_newbcast:3 row_mask:0xf bank_mask:0xf
  v_and_b32_dpp v49, v57, v81 row_newbcast:3 row_mask:0xf bank_mask:0xf
  v_and_b32_dpp v50, v57, v82 row_newbcast:3 row_mask:0xf bank_mask:0xf
  v_and_b32_dpp v51, v57, v83 row_newbcast:3 row_mask:0xf bank_mask:0xf
  s_waitcnt vmcnt(11)
  v_mfma_f32_16x16x32_bf16 v[44:47], a[44:47], v[52:55], v[44:47]
  s_add_u32 s58, s47, 71680
  buffer_load_dwordx4 a[108:111], v75, s[36:39], s58 offen nt
  v_and_b32_dpp v52, v57, v80 row_newbcast:7 row_mask:0xf bank_mask:0xf
  v_and_b32_dpp v53, v57, v81 row_newbcast:7 row_mask:0xf bank_mask:0xf
  v_and_b32_dpp v54, v57, v82 row_newbcast:7 row_mask:0xf bank_mask:0xf
  v_and_b32_dpp v55, v57, v83 row_newbcast:7 row_mask:0xf bank_mask:0xf
  s_waitcnt vmcnt(12)
  v_mfma_f32_16x16x32_bf16 v[44:47], a[48:51], v[48:51], v[44:47]
  s_add_u32 s58, s47, 73728
  buffer_load_dwordx4 a[112:115], v75, s[36:39], s58 offen nt
  v_and_b32_dpp v48, v57, v80 row_newbcast:11 row_mask:0xf bank_mask:0xf
  v_and_b32_dpp v49, v57, v81 row_newbcast:11 row_mask:0xf bank_mask:0xf
  v_and_b32_dpp v50, v57, v82 row_newbcast:11 row_mask:0xf bank_mask:0xf
  v_and_b32_dpp v51, v57, v83 row_newbcast:11 row_mask:0xf bank_mask:0xf
  s_waitcnt vmcnt(13)
  v_mfma_f32_16x16x32_bf16 v[44:47], a[52:55], v[52:55], v[44:47]
  s_add_u32 s58, s47, 75776
  buffer_load_dwordx4 a[116:119], v75, s[36:39], s58 offen nt
  v_and_b32_dpp v52, v57, v80 row_newbcast:15 row_mask:0xf bank_mask:0xf
  v_and_b32_dpp v53, v57, v81 row_newbcast:15 row_mask:0xf bank_mask:0xf
  v_and_b32_dpp v54, v57, v82 row_newbcast:15 row_mask:0xf bank_mask:0xf
  v_and_b32_dpp v55, v57, v83 row_newbcast:15 row_mask:0xf bank_mask:0xf
  s_waitcnt vmcnt(14)
  v_mfma_f32_16x16x32_bf16 v[44:47], a[56:59], v[48:51], v[44:47]
  s_add_u32 s58, s47, 77824
  buffer_load_dwordx4 a[120:123], v75, s[36:39], s58 offen nt
  s_waitcnt vmcnt(15)
  v_mfma_f32_16x16x32_bf16 v[44:47], a[60:63], v[52:55], v[44:47]
  s_add_u32 s58, s47, 79872
  buffer_load_dwordx4 a[124:127], v75, s[36:39], s58 offen nt
  s_nop 5
  v_mul_f32 v44, v44, v68
  v_mul_f32 v45, v45, v68
  v_mul_f32 v46, v46, v68
  v_mul_f32 v47, v47, v68
  ds_write_b128 v77, v[44:47] offset:33792
  ds_write_b32 v74, v69 offset:280
  s_mov_b32 s70, 1600000
L_oc:
  ds_read_b32 v60, v58 offset:280
  ds_read_b128 v[64:67], v78 offset:33792
  s_waitcnt lgkmcnt(0)
  v_cmp_eq_u32 vcc, 0, v60
  s_cbranch_vccz L_oc_ok
  s_sub_u32 s70, s70, 1
  s_cmp_lg_u32 s70, 0
  s_cbranch_scc1 L_oc
L_oc_ok:
  v_add_f32 v44, v44, v64
  v_add_f32 v45, v45, v65
  v_add_f32 v46, v46, v66
  v_add_f32 v47, v47, v67
  v_bfi_b32 v64, v85, s14, v44
  v_bfi_b32 v65, v85, s15, v45
  v_bfi_b32 v66, v85, s24, v46
  v_bfi_b32 v67, v85, s25, v47
  buffer_store_dwordx4 v[64:67], v86, s[28:31], s4 offen sc0 sc1
  s_mov_b32 s70, 200000
L_og:
  s_sleep 3
  buffer_load_dwordx4 v[88:91], v76, s[28:31], s5 offen offset:0 sc1
  buffer_load_dwordx4 v[92:95], v76, s[28:31], s5 offen offset:2048 sc1
  s_waitcnt vmcnt(0)
  v_xor_b32 v88, s14, v88
  v_xor_b32 v89, s15, v89
  v_xor_b32 v90, s24, v90
  v_xor_b32 v91, s25, v91
  v_xor_b32 v92, s14, v92
  v_xor_b32 v93, s15, v93
  v_xor_b32 v94, s24, v94
  v_xor_b32 v95, s25, v95
  v_or3_b32 v32, v88, v89, v90
  v_or3_b32 v33, v91, v92, v93
  v_or3_b32 v34, v94, v95, v32
  v_or_b32 v35, v33, v34
  v_and_b32 v35, v85, v35
  v_cmp_ne_u32 vcc, 0, v35
  s_cbranch_vccz L_og_ok
  s_wqm_b64 exec, vcc
  s_sub_u32 s70, s70, 1
  s_cmp_lg_u32 s70, 0
  s_cbranch_scc1 L_og
L_og_ok:
  s_mov_b64 exec, -1
  v_add_f32 v32, v88, v92
  v_add_f32 v33, v89, v93
  v_add_f32 v34, v90, v94
  v_add_f32 v35, v91, v95
  s_nop 0
  v_permlane32_swap_b32 v32, v34
  v_permlane32_swap_b32 v33, v35
  v_add_f32 v32, v32, v34
  v_add_f32 v33, v33, v35
  s_nop 1
  v_permlane16_swap_b32 v32, v33
  v_add_f32 v32, v32, v33
  v_cvt_pk_bf16_f32 v57, v32, v32
  s_nop 1
  v_and_b32_dpp v48, v57, v80 row_newbcast:0 row_mask:0xf bank_mask:0xf
  v_and_b32_dpp v49, v57, v81 row_newbcast:0 row_mask:0xf bank_mask:0xf
  v_and_b32_dpp v50, v57, v82 row_newbcast:0 row_mask:0xf bank_mask:0xf
  v_and_b32_dpp v51, v57, v83 row_newbcast:0 row_mask:0xf bank_mask:0xf
  v_and_b32_dpp v52, v57, v80 row_newbcast:1 row_mask:0xf bank_mask:0xf
  v_and_b32_dpp v53, v57, v81 row_newbcast:1 row_mask:0xf bank_mask:0xf
  v_and_b32_dpp v54, v57, v82 row_newbcast:1 row_mask:0xf bank_mask:0xf
  v_and_b32_dpp v55, v57, v83 row_newbcast:1 row_mask:0xf bank_mask:0xf
  v_mfma_f32_16x16x32_bf16 v[28:31], a[64:67], v[48:51], 0
  v_and_b32_dpp v48, v57, v80 row_newbcast:2 row_mask:0xf bank_mask:0xf
  v_and_b32_dpp v49, v57, v81 row_newbcast:2 row_mask:0xf bank_mask:0xf
  v_and_b32_dpp v50, v57, v82 row_newbcast:2 row_mask:0xf bank_mask:0xf
  v_and_b32_dpp v51, v57, v83 row_newbcast:2 row_mask:0xf bank_mask:0xf
  v_mfma_f32_16x16x32_bf16 v[28:31], a[68:71], v[52:55], v[28:31]
  v_and_b32_dpp v52, v57, v80 row_newbcast:3 row_mask:0xf bank_mask:0xf
  v_and_b32_dpp v53, v57, v81 row_newbcast:3 row_mask:0xf bank_mask:0xf
  v_and_b32_dpp v54, v57, v82 row_newbcast:3 row_mask:0xf bank_mask:0xf
  v_and_b32_dpp v55, v57, v83 row_newbcast:3 row_mask:0xf bank_mask:0xf
  v_mfma_f32_16x16x32_bf16 v[28:31], a[72:75], v[48:51], v[28:31]
  v_and_b32_dpp v48, v57, v80 row_newbcast:4 row_mask:0xf bank_mask:0xf
  v_and_b32_dpp v49, v57, v81 row_newbcast:4 row_mask:0xf bank_mask:0xf
  v_and_b32_dpp v50, v57, v82 row_newbcast:4 row_mask:0xf bank_mask:0xf
  v_and_b32_dpp v51, v57, v83 row_newbcast:4 row_mask:0xf bank_mask:0xf
  v_mfma_f32_16x16x32_bf16 v[28:31], a[76:79], v[52:55], v[28:31]
  v_and_b32_dpp v52, v57, v80 row_newbcast:5 row_mask:0xf bank_mask:0xf
  v_and_b32_dpp v53, v57, v81 row_newbcast:5 row_mask:0xf bank_mask:0xf
  v_and_b32_dpp v54, v57, v82 row_newbcast:5 row_mask:0xf bank_mask:0xf
  v_and_b32_dpp v55, v57, v83 row_newbcast:5 row_mask:0xf bank_mask:0xf
  v_mfma_f32_16x16x32_bf16 v[28:31], a[80:83], v[48:51], v[28:31]
  v_and_b32_dpp v48, v57, v80 row_newbcast:6 row_mask:0xf bank_mask:0xf
  v_and_b32_dpp v49, v57, v81 row_newbcast:6 row_mask:0xf bank_mask:0xf
  v_and_b32_dpp v50, v57, v82 row_newbcast:6 row_mask:0xf bank_mask:0xf
  v_and_b32_dpp v51, v57, v83 row_newbcast:6 row_mask:0xf bank_mask:0xf
  v_mfma_f32_16x16x32_bf16 v[28:31], a[84:87], v[52:55], v[28:31]
  v_and_b32_dpp v52, v57, v80 row_newbcast:7 row_mask:0xf bank_mask:0xf
  v_and_b32_dpp v53, v57, v81 row_newbcast:7 row_mask:0xf bank_mask:0xf
  v_and_b32_dpp v54, v57, v82 row_newbcast:7 row_mask:0xf bank_mask:0xf
  v_and_b32_dpp v55, v57, v83 row_newbcast:7 row_mask:0xf bank_mask:0xf
  v_mfma_f32_16x16x32_bf16 v[28:31], a[88:91], v[48:51], v[28:31]
  v_and_b32_dpp v48, v57, v80 row_newbcast:8 row_mask:0xf bank_mask:0xf
  v_and_b32_dpp v49, v57, v81 row_newbcast:8 row_mask:0xf bank_mask:0xf
  v_and_b32_dpp v50, v57, v82 row_newbcast:8 row_mask:0xf bank_mask:0xf
  v_and_b32_dpp v51, v57, v83 row_newbcast:8 row_mask:0xf bank_mask:0xf
  v_mfma_f32_16x16x32_bf16 v[28:31], a[92:95], v[52:55], v[28:31]
  v_and_b32_dpp v52, v57, v80 row_newbcast:9 row_mask:0xf bank_mask:0xf
  v_and_b32_dpp v53, v57, v81 row_newbcast:9 row_mask:0xf bank_mask:0xf
  v_and_b32_dpp v54, v57, v82 row_newbcast:9 row_mask:0xf bank_mask:0xf
  v_and_b32_dpp v55, v57, v83 row_newbcast:9 row_mask:0xf bank_mask:0xf
  v_mfma_f32_16x16x32_bf16 v[28:31], a[96:99], v[48:51], v[28:31]
  v_and_b32_dpp v48, v57, v80 row_newbcast:10 row_mask:0xf bank_mask:0xf
  v_and_b32_dpp v49, v57, v81 row_newbcast:10 row_mask:0xf bank_mask:0xf
  v_and_b32_dpp v50, v57, v82 row_newbcast:10 row_mask:0xf bank_mask:0xf
  v_and_b32_dpp v51, v57, v83 row_newbcast:10 row_mask:0xf bank_mask:0xf
  v_mfma_f32_16x16x32_bf16 v[28:31], a[100:103], v[52:55], v[28:31]
  v_and_b32_dpp v52, v57, v80 row_newbcast:11 row_mask:0xf bank_mask:0xf
  v_and_b32_dpp v53, v57, v81 row_newbcast:11 row_mask:0xf bank_mask:0xf
  v_and_b32_dpp v54, v57, v82 row_newbcast:11 row_mask:0xf bank_mask:0xf
  v_and_b32_dpp v55, v57, v83 row_newbcast:11 row_mask:0xf bank_mask:0xf
  v_mfma_f32_16x16x32_bf16 v[28:31], a[104:107], v[48:51], v[28:31]
  v_and_b32_dpp v48, v57, v80 row_newbcast:12 row_mask:0xf bank_mask:0xf
  v_and_b32_dpp v49, v57, v81 row_newbcast:12 row_mask:0xf bank_mask:0xf
  v_and_b32_dpp v50, v57, v82 row_newbcast:12 row_mask:0xf bank_mask:0xf
  v_and_b32_dpp v51, v57, v83 row_newbcast:12 row_mask:0xf bank_mask:0xf
  v_mfma_f32_16x16x32_bf16 v[28:31], a[108:111], v[52:55], v[28:31]
  v_and_b32_dpp v52, v57, v80 row_newbcast:13 row_mask:0xf bank_mask:0xf
  v_and_b32_dpp v53, v57, v81 row_newbcast:13 row_mask:0xf bank_mask:0xf
  v_and_b32_dpp v54, v57, v82 row_newbcast:13 row_mask:0xf bank_mask:0xf
  v_and_b32_dpp v55, v57, v83 row_newbcast:13 row_mask:0xf bank_mask:0xf
  v_mfma_f32_16x16x32_bf16 v[28:31], a[112:115], v[48:51], v[28:31]
  v_and_b32_dpp v48, v57, v80 row_newbcast:14 row_mask:0xf bank_mask:0xf
  v_and_b32_dpp v49, v57, v81 row_newbcast:14 row_mask:0xf bank_mask:0xf
  v_and_b32_dpp v50, v57, v82 row_newbcast:14 row_mask:0xf bank_mask:0xf
  v_and_b32_dpp v51, v57, v83 row_newbcast:14 row_mask:0xf bank_mask:0xf
  v_mfma_f32_16x16x32_bf16 v[28:31], a[116:119], v[52:55], v[28:31]
  v_and_b32_dpp v52, v57, v80 row_newbcast:15 row_mask:0xf bank_mask:0xf
  v_and_b32_dpp v53, v57, v81 row_newbcast:15 row_mask:0xf bank_mask:0xf
  v_and_b32_dpp v54, v57, v82 row_newbcast:15 row_mask:0xf bank_mask:0xf
  v_and_b32_dpp v55, v57, v83 row_newbcast:15 row_mask:0xf bank_mask:0xf
  v_mfma_f32_16x16x32_bf16 v[28:31], a[120:123], v[48:51], v[28:31]
  s_nop 0
  v_mfma_f32_16x16x32_bf16 v[28:31], a[124:127], v[52:55], v[28:31]
  s_nop 7
  v_bfi_b32 v64, v85, s14, v28
  v_bfi_b32 v65, v85, s15, v29
  v_bfi_b32 v66, v85, s24, v30
  v_bfi_b32 v67, v85, s25, v31
  buffer_store_dwordx4 v[64:67], v84, s[28:31], s8 offen
  buffer_store_dwordx4 v[64:67], v84, s[28:31], s7 offen sc0 sc1
  ds_write_b32 v73, v69 offset:304
L_sfin:
L_fin:
L_end:
  s_endpgm
L_codeend:
.section .rodata,"a"
.p2align 6
.amdhsa_kernel parallel_sum__mha_block_cached__glu_gated_glu__decode_kernel
  .amdhsa_next_free_vgpr 256
  .amdhsa_next_free_sgpr 102
  .amdhsa_accum_offset 128
  .amdhsa_group_segment_fixed_size 0
  .amdhsa_kernarg_size 96
  .amdhsa_user_sgpr_count 2
  .amdhsa_user_sgpr_kernarg_segment_ptr 1
  .amdhsa_system_sgpr_workgroup_id_x 1
.end_amdhsa_kernel
```
